```python
import torch

def _softmax(x, axis=-1):
    return torch.softmax(x, dim=axis)
def _gelu(x):
    return torch.nn.functional.gelu(x, approximate="tanh")
def _silu(x):
    return torch.nn.functional.silu(x)
def _sigmoid(x):
    return torch.sigmoid(x)
def _layernorm(x, axis=-1, eps=1e-5):
    m = x.mean(dim=axis, keepdim=True)
    v = x.var(dim=axis, keepdim=True, unbiased=False)
    return (x - m) / torch.sqrt(v + eps)
def _scatter_add(tgt, idx, src, axis=0):
    return tgt.clone().index_add_(axis, idx, src)
def _segment_sum(src, seg, n):
    out = torch.zeros((n,) + src.shape[1:], dtype=src.dtype)
    return out.index_add_(0, seg, src)
def _pad(x, pw):
    flat = tuple(v for pair in reversed(pw) for v in pair)
    return torch.nn.functional.pad(x, flat)

kernel_name = 'interleave_layers__sliding_block__glu_gated_bilinear__prompt'

def setup_inputs():

    _w = (lambda a: (lambda t: t.to(torch.bfloat16) if t.is_floating_point() else t)(torch.as_tensor(a)))
    def _A_setup():
        B, S, D = 1, 2048, 448
        return {
            "x": _w((lambda *s: torch.randn(*s, dtype=torch.bfloat16) * 0.05)(B, S, D)),
            "wqkv": _w((lambda *s: torch.randn(*s, dtype=torch.bfloat16) * 0.05)(D, 3 * D)),
            "wo": _w((lambda *s: torch.randn(*s, dtype=torch.bfloat16) * 0.05)(D, D)),
        }
    _A_in = _A_setup()

    def _B_setup():
        B, S, D, F = 1, 2048, 448, 1792
        return {
            "x": _w((lambda *s: torch.randn(*s, dtype=torch.bfloat16) * 0.05)(B, S, D)),
            "w_gate": _w((lambda *s: torch.randn(*s, dtype=torch.bfloat16) * 0.8)(D, F) * (D ** -0.5)),
            "w_up": _w((lambda *s: torch.randn(*s, dtype=torch.bfloat16) * 0.8)(D, F) * (D ** -0.5)),
            "w_down": _w((lambda *s: torch.randn(*s, dtype=torch.bfloat16) * 0.8)(F, D) * (F ** -0.5)),
        }
    _B_in = _B_setup()

    return {
        "A_x": _A_in["x"],
        "A_wqkv": _A_in["wqkv"],
        "A_wo": _A_in["wo"],
        "B_x": _B_in["x"],
        "B_w_gate": _B_in["w_gate"],
        "B_w_up": _B_in["w_up"],
        "B_w_down": _B_in["w_down"],
    }

def reference(A_x, A_wqkv, A_wo, B_x, B_w_gate, B_w_up, B_w_down):
    def _A_ref(x, wqkv, wo):
        B, S, D = x.shape
        H = 16; Dh = D // H; W = 256
        qkv = (lambda x, *d: x.permute(*d))((x @ wqkv).reshape(B, S, 3, H, Dh), 2, 0, 3, 1, 4)
        q, k, v = qkv[0], qkv[1], qkv[2]
        scores = torch.einsum("bhqd,bhkd->bhqk", q, k) * (Dh ** -0.5)
        idx = torch.arange(S)
        mask = (idx[:, None] - idx[None, :] >= 0) & (idx[:, None] - idx[None, :] < W)
        scores = torch.where(mask[None, None], scores, -1e9)
        p = _softmax(scores, axis=-1)
        o = torch.einsum("bhqk,bhkd->bhqd", p, v)
        return (lambda x, *d: x.permute(*d))(o, 0, 2, 1, 3).reshape(B, S, D) @ wo

    def _B_ref(x, w_gate, w_up, w_down):
        g = torch.einsum("bsd,df->bsf", x, w_gate)
        u = torch.einsum("bsd,df->bsf", x, w_up)
        h = g * u
        return torch.einsum("bsf,fd->bsd", h, w_down)

    x = A_x
    x = x + _A_ref(_layernorm(x, axis=-1), A_wqkv, A_wo)
    x = x + _B_ref(_layernorm(x, axis=-1), B_w_gate, B_w_up, B_w_down)
    x = x + _A_ref(_layernorm(x, axis=-1), A_wqkv, A_wo)
    x = x + _B_ref(_layernorm(x, axis=-1), B_w_gate, B_w_up, B_w_down)
    return x
```

```asm
; @launch kernel=prep_kernel grid=(368,1,1) block=(256,1,1) lds=38912
; @launch kernel=mega_kernel grid=(256,1,1) block=(256,1,1) lds=115712
.amdgcn_target "amdgcn-amd-amdhsa--gfx950"
.text
.globl prep_kernel
.p2align 8
.type prep_kernel,@function
prep_kernel:
    s_cmp_ge_u32 s2, 368
    s_cbranch_scc1 L_prep_end2
    s_load_dwordx16 s[8:23], s[0:1], 0
    s_load_dwordx2 s[28:29], s[0:1], 72
    v_lshrrev_b32 v1, 6, v0
    v_and_b32 v2, 63, v0
    v_and_b32 v3, 15, v0
    v_bfe_u32 v4, v0, 4, 2
    v_readfirstlane_b32 s3, v1
    v_lshlrev_b32 v5, 4, v2
    s_mov_b32 s30, 0x6000000
    s_mov_b32 s31, 0x20000
    s_mov_b32 s7, 0x20000
    s_mov_b32 s39, 0x3f803f80
    v_mov_b32 v15, 0x40000000
    v_lshrrev_b32 v14, 2, v3
    s_lshr_b32 s55, s2, 2
    s_and_b32 s53, s2, 3
    s_lshl_b32 s53, s53, 2
    s_add_u32 s53, s53, s3
    s_waitcnt lgkmcnt(0)
    s_cmp_ge_u32 s2, 240
    s_cbranch_scc1 L_prep_x
    s_cmp_ge_u32 s55, 56
    s_cbranch_scc1 L_prep_wo
    s_cmp_ge_u32 s55, 40
    s_cbranch_scc1 L_prep_wd
    s_cmp_ge_u32 s55, 12
    s_cbranch_scc1 L_prep_gu
    s_lshr_b32 s40, s55, 2
    s_and_b32 s41, s55, 3
    s_mov_b32 s4, s10
    s_mov_b32 s5, s11
    s_mov_b32 s6, 1204224
    s_mov_b32 s32, 2688
    s_mov_b32 s33, 86016
    s_mov_b32 s38, 0
    s_mov_b32 s35, 6144
    s_mov_b32 s36, 14
    s_mov_b32 s50, 86016
    s_mov_b32 s51, 1024
    s_mov_b32 s52, 8
    s_lshl_b32 s42, s41, 2
    v_add_u32 v6, s42, v14
    v_mul_u32_u24 v7, 28, v6
    v_and_b32 v8, 3, v3
    v_lshl_add_u32 v7, v8, 3, v7
    s_mul_i32 s42, s40, 448
    v_add_u32 v7, s42, v7
    v_lshlrev_b32 v7, 1, v7
    v_mul_u32_u24 v8, 10752, v4
    v_add_u32 v7, v7, v8
    v_add_u32 v9, 43008, v7
    s_mul_i32 s34, s41, 344064
    s_lshl_b32 s42, s40, 11
    s_add_u32 s34, s34, s42
    s_add_u32 s34, s34, 0x800000
    s_lshl_b32 s42, s41, 2
    v_add_u32 v11, s42, v4
    v_mul_u32_u24 v11, 384, v11
    v_lshl_add_u32 v11, v3, 3, v11
    s_lshl_b32 s49, s40, 7
    s_add_u32 s49, s49, 0x1100000
    s_mov_b32 s48, 1
    s_mov_b32 s37, 0
    s_branch L_prep_go
L_prep_gu:
    s_sub_u32 s40, s55, 12
    s_cmp_ge_u32 s40, 14
    s_cselect_b32 s41, 1, 0
    s_cselect_b32 s4, s18, s16
    s_cselect_b32 s5, s19, s17
    s_mul_i32 s42, s41, 14
    s_sub_u32 s40, s40, s42
    s_mov_b32 s6, 1605632
    s_mov_b32 s32, 3584
    s_mov_b32 s33, 114688
    s_mov_b32 s38, 0
    s_mov_b32 s35, 4096
    s_mov_b32 s36, 14
    s_mov_b32 s50, 57344
    s_mov_b32 s51, 1024
    s_mov_b32 s52, 8
    s_lshl_b32 s42, s40, 8
    v_lshl_add_u32 v7, v3, 4, s42
    v_mul_u32_u24 v8, 14336, v4
    v_add_u32 v7, v7, v8
    v_add_u32 v9, 57344, v7
    s_mul_i32 s34, s40, 229376
    s_lshl_b32 s42, s41, 11
    s_add_u32 s34, s34, s42
    s_add_u32 s34, s34, 0xb00000
    v_lshlrev_b32 v11, 3, v2
    s_lshl_b32 s49, s40, 9
    s_lshl_b32 s42, s41, 13
    s_add_u32 s49, s49, s42
    s_add_u32 s49, s49, 0x1102000
    s_mov_b32 s48, 0
    s_mov_b32 s37, 0
    s_branch L_prep_go
L_prep_wd:
    s_sub_u32 s40, s55, 40
    s_and_b32 s41, s40, 3
    s_lshr_b32 s40, s40, 2
    s_mov_b32 s4, s20
    s_mov_b32 s5, s21
    s_mov_b32 s6, 1605632
    s_mov_b32 s32, 896
    s_mov_b32 s33, 28672
    s_mul_i32 s38, s41, 401408
    s_mov_b32 s35, 1024
    s_mov_b32 s36, 14
    s_mov_b32 s50, 114688
    s_mov_b32 s51, 57344
    s_cmp_eq_u32 s40, 3
    s_cselect_b32 s52, 4, 8
    s_lshl_b32 s42, s40, 8
    v_lshl_add_u32 v7, v3, 4, s42
    v_mul_u32_u24 v8, 3584, v4
    v_add_u32 v7, v7, v8
    v_add_u32 v9, 14336, v7
    s_mul_i32 s34, s40, 458752
    s_mul_i32 s42, s41, 14336
    s_add_u32 s34, s34, s42
    s_add_u32 s34, s34, 0xf00000
    s_mov_b32 s48, 0
    s_mov_b32 s49, 0
    s_mov_b32 s37, -1
    v_mov_b32 v11, 0
    s_branch L_prep_go
L_prep_wo:
    s_sub_u32 s40, s55, 56
    s_mov_b32 s4, s12
    s_mov_b32 s5, s13
    s_mov_b32 s6, 401408
    s_mov_b32 s32, 896
    s_mov_b32 s33, 25088
    s_mov_b32 s38, 0
    s_mov_b32 s35, 1024
    s_mov_b32 s36, 16
    s_mov_b32 s50, 32768
    s_mov_b32 s51, 16384
    s_cmp_eq_u32 s40, 3
    s_cselect_b32 s52, 4, 8
    s_lshl_b32 s42, s40, 8
    v_lshl_add_u32 v7, v3, 4, s42
    v_mul_u32_u24 v8, 3584, v4
    v_add_u32 v7, v7, v8
    v_add_u32 v9, 14336, v7
    v_cmp_gt_u32 vcc, 3, v4
    s_lshl_b32 s34, s40, 17
    s_add_u32 s34, s34, 0xa00000
    s_mov_b32 s48, 0
    s_mov_b32 s49, 0
    s_mov_b32 s37, -1
    v_mov_b32 v11, 0
    v_cndmask_b32 v9, v15, v9, vcc
L_prep_go:
    v_and_b32 v8, 3, v3
    v_cmp_ne_u32 s[56:57], 3, v8
    v_mov_b32 v16, 0
    v_mov_b32 v17, 0
    v_mov_b32 v18, 0
    v_mov_b32 v19, 0
    v_mov_b32 v20, 0
    v_mov_b32 v21, 0
    v_mov_b32 v22, 0
    v_mov_b32 v23, 0
    s_cmp_ge_u32 s53, s36
    s_cbranch_scc1 L_prep_cs
    s_mul_i32 s45, s53, s33
    s_add_u32 s45, s45, s38
    s_add_u32 s46, s45, s32
    s_add_u32 s47, s46, s32
    s_add_u32 s54, s47, s32
    buffer_load_dwordx4 v[32:35], v7, s[4:7], s45 offen
    buffer_load_dwordx4 v[36:39], v7, s[4:7], s46 offen
    buffer_load_dwordx4 v[40:43], v7, s[4:7], s47 offen
    buffer_load_dwordx4 v[44:47], v7, s[4:7], s54 offen
    buffer_load_dwordx4 v[48:51], v9, s[4:7], s45 offen
    buffer_load_dwordx4 v[52:55], v9, s[4:7], s46 offen
    buffer_load_dwordx4 v[56:59], v9, s[4:7], s47 offen
    buffer_load_dwordx4 v[60:63], v9, s[4:7], s54 offen
    s_mul_i32 s44, s3, 9216
    v_mul_u32_u24 v12, 1152, v4
    v_lshl_add_u32 v12, v3, 4, v12
    v_add_u32 v12, s44, v12
    v_lshl_add_u32 v13, v4, 2, v14
    v_mul_u32_u24 v13, 288, v13
    v_lshl_add_u32 v13, v8, 3, v13
    v_add_u32 v13, s44, v13
    s_waitcnt vmcnt(0)
    s_cmp_eq_u32 s48, 0
    s_cbranch_scc1 L_prep_nopad
    v_cndmask_b32 v34, 0, v34, s[56:57]
    v_cndmask_b32 v35, 0, v35, s[56:57]
    v_cndmask_b32 v38, 0, v38, s[56:57]
    v_cndmask_b32 v39, 0, v39, s[56:57]
    v_cndmask_b32 v42, 0, v42, s[56:57]
    v_cndmask_b32 v43, 0, v43, s[56:57]
    v_cndmask_b32 v46, 0, v46, s[56:57]
    v_cndmask_b32 v47, 0, v47, s[56:57]
    v_cndmask_b32 v50, 0, v50, s[56:57]
    v_cndmask_b32 v51, 0, v51, s[56:57]
    v_cndmask_b32 v54, 0, v54, s[56:57]
    v_cndmask_b32 v55, 0, v55, s[56:57]
    v_cndmask_b32 v58, 0, v58, s[56:57]
    v_cndmask_b32 v59, 0, v59, s[56:57]
    v_cndmask_b32 v62, 0, v62, s[56:57]
    v_cndmask_b32 v63, 0, v63, s[56:57]
L_prep_nopad:
    ds_write_b128 v12, v[32:35] offset:0
    ds_write_b128 v12, v[48:51] offset:4608
    ds_write_b128 v12, v[36:39] offset:288
    ds_write_b128 v12, v[52:55] offset:4896
    ds_write_b128 v12, v[40:43] offset:576
    ds_write_b128 v12, v[56:59] offset:5184
    ds_write_b128 v12, v[44:47] offset:864
    ds_write_b128 v12, v[60:63] offset:5472
    s_waitcnt lgkmcnt(0)
    ds_read_b64_tr_b16 v[64:65], v13 offset:0
    ds_read_b64_tr_b16 v[66:67], v13 offset:4608
    ds_read_b64_tr_b16 v[68:69], v13 offset:32
    ds_read_b64_tr_b16 v[70:71], v13 offset:4640
    ds_read_b64_tr_b16 v[72:73], v13 offset:64
    ds_read_b64_tr_b16 v[74:75], v13 offset:4672
    ds_read_b64_tr_b16 v[76:77], v13 offset:96
    ds_read_b64_tr_b16 v[78:79], v13 offset:4704
    ds_read_b64_tr_b16 v[80:81], v13 offset:128
    ds_read_b64_tr_b16 v[82:83], v13 offset:4736
    ds_read_b64_tr_b16 v[84:85], v13 offset:160
    ds_read_b64_tr_b16 v[86:87], v13 offset:4768
    ds_read_b64_tr_b16 v[88:89], v13 offset:192
    ds_read_b64_tr_b16 v[90:91], v13 offset:4800
    ds_read_b64_tr_b16 v[92:93], v13 offset:224
    ds_read_b64_tr_b16 v[94:95], v13 offset:4832
    s_mul_i32 s45, s53, s35
    s_add_u32 s45, s45, s34
    s_waitcnt lgkmcnt(0)
    buffer_store_dwordx4 v[64:67], v5, s[28:31], s45 offen
    v_dot2c_f32_bf16 v16, s39, v64
    v_dot2c_f32_bf16 v16, s39, v65
    v_dot2c_f32_bf16 v16, s39, v66
    v_dot2c_f32_bf16 v16, s39, v67
    s_add_u32 s46, s45, s51
    buffer_store_dwordx4 v[68:71], v5, s[28:31], s46 offen
    s_add_u32 s45, s45, s50
    v_dot2c_f32_bf16 v17, s39, v68
    v_dot2c_f32_bf16 v17, s39, v69
    v_dot2c_f32_bf16 v17, s39, v70
    v_dot2c_f32_bf16 v17, s39, v71
    buffer_store_dwordx4 v[72:75], v5, s[28:31], s45 offen
    v_dot2c_f32_bf16 v18, s39, v72
    v_dot2c_f32_bf16 v18, s39, v73
    v_dot2c_f32_bf16 v18, s39, v74
    v_dot2c_f32_bf16 v18, s39, v75
    s_add_u32 s46, s45, s51
    buffer_store_dwordx4 v[76:79], v5, s[28:31], s46 offen
    s_add_u32 s45, s45, s50
    v_dot2c_f32_bf16 v19, s39, v76
    v_dot2c_f32_bf16 v19, s39, v77
    v_dot2c_f32_bf16 v19, s39, v78
    v_dot2c_f32_bf16 v19, s39, v79
    s_cmp_le_u32 s52, 4
    s_cbranch_scc1 L_prep_end
    buffer_store_dwordx4 v[80:83], v5, s[28:31], s45 offen
    v_dot2c_f32_bf16 v20, s39, v80
    v_dot2c_f32_bf16 v20, s39, v81
    v_dot2c_f32_bf16 v20, s39, v82
    v_dot2c_f32_bf16 v20, s39, v83
    s_add_u32 s46, s45, s51
    buffer_store_dwordx4 v[84:87], v5, s[28:31], s46 offen
    s_add_u32 s45, s45, s50
    v_dot2c_f32_bf16 v21, s39, v84
    v_dot2c_f32_bf16 v21, s39, v85
    v_dot2c_f32_bf16 v21, s39, v86
    v_dot2c_f32_bf16 v21, s39, v87
    buffer_store_dwordx4 v[88:91], v5, s[28:31], s45 offen
    v_dot2c_f32_bf16 v22, s39, v88
    v_dot2c_f32_bf16 v22, s39, v89
    v_dot2c_f32_bf16 v22, s39, v90
    v_dot2c_f32_bf16 v22, s39, v91
    s_add_u32 s46, s45, s51
    buffer_store_dwordx4 v[92:95], v5, s[28:31], s46 offen
    s_add_u32 s45, s45, s50
    v_dot2c_f32_bf16 v23, s39, v92
    v_dot2c_f32_bf16 v23, s39, v93
    v_dot2c_f32_bf16 v23, s39, v94
    v_dot2c_f32_bf16 v23, s39, v95
L_prep_cs:
    s_cmp_eq_u32 s37, -1
    s_cbranch_scc1 L_prep_end
    s_nop 3
    v_mov_b32 v24, v16
    v_mov_b32 v25, v17
    v_mov_b32 v26, v18
    v_mov_b32 v27, v19
    v_mov_b32 v28, v20
    v_mov_b32 v29, v21
    v_mov_b32 v30, v22
    v_mov_b32 v31, v23
    v_permlane16_swap_b32 v16, v24
    v_permlane16_swap_b32 v17, v25
    v_permlane16_swap_b32 v18, v26
    v_permlane16_swap_b32 v19, v27
    v_permlane16_swap_b32 v20, v28
    v_permlane16_swap_b32 v21, v29
    v_permlane16_swap_b32 v22, v30
    v_permlane16_swap_b32 v23, v31
    v_add_f32 v16, v16, v24
    v_add_f32 v17, v17, v25
    v_add_f32 v18, v18, v26
    v_add_f32 v19, v19, v27
    v_add_f32 v20, v20, v28
    v_add_f32 v21, v21, v29
    v_add_f32 v22, v22, v30
    v_add_f32 v23, v23, v31
    v_mov_b32 v24, v16
    v_mov_b32 v25, v17
    v_mov_b32 v26, v18
    v_mov_b32 v27, v19
    v_mov_b32 v28, v20
    v_mov_b32 v29, v21
    v_mov_b32 v30, v22
    v_mov_b32 v31, v23
    v_permlane32_swap_b32 v16, v24
    v_permlane32_swap_b32 v17, v25
    v_permlane32_swap_b32 v18, v26
    v_permlane32_swap_b32 v19, v27
    v_permlane32_swap_b32 v20, v28
    v_permlane32_swap_b32 v21, v29
    v_permlane32_swap_b32 v22, v30
    v_permlane32_swap_b32 v23, v31
    v_add_f32 v16, v16, v24
    v_add_f32 v17, v17, v25
    v_add_f32 v18, v18, v26
    v_add_f32 v19, v19, v27
    v_add_f32 v20, v20, v28
    v_add_f32 v21, v21, v29
    v_add_f32 v22, v22, v30
    v_add_f32 v23, v23, v31
    s_lshl_b32 s44, s3, 9
    s_add_u32 s44, s44, 36864
    v_lshl_add_u32 v24, v3, 2, s44
    ds_write_b32 v24, v16 offset:0
    ds_write_b32 v24, v17 offset:64
    ds_write_b32 v24, v18 offset:128
    ds_write_b32 v24, v19 offset:192
    ds_write_b32 v24, v20 offset:256
    ds_write_b32 v24, v21 offset:320
    ds_write_b32 v24, v22 offset:384
    ds_write_b32 v24, v23 offset:448
    s_waitcnt lgkmcnt(0)
    s_barrier
    s_cmp_lg_u32 s3, 0
    s_cbranch_scc1 L_prep_end
    v_lshlrev_b32 v24, 3, v2
    v_add_u32 v24, 36864, v24
    ds_read_b64 v[32:33], v24 offset:0
    ds_read_b64 v[34:35], v24 offset:512
    ds_read_b64 v[36:37], v24 offset:1024
    ds_read_b64 v[38:39], v24 offset:1536
    s_and_b32 s44, s2, 3
    s_lshl_b32 s44, s44, 15
    s_add_u32 s49, s49, s44
    s_waitcnt lgkmcnt(0)
    v_pk_add_f32 v[32:33], v[32:33], v[34:35]
    v_pk_add_f32 v[36:37], v[36:37], v[38:39]
    v_pk_add_f32 v[32:33], v[32:33], v[36:37]
    buffer_store_dwordx2 v[32:33], v11, s[28:31], s49 offen
    s_branch L_prep_end
L_prep_x:
    s_sub_u32 s40, s2, 240
    v_mov_b32 v16, 0
    v_mov_b32 v17, 0
    v_mov_b32 v18, 0
    v_mov_b32 v19, 0
    s_cmp_ge_u32 s40, 64
    s_cselect_b32 s42, 0x17f0000, 0
    s_lshl_b32 s41, s40, 10
    s_add_u32 s41, s41, s42
    s_add_u32 s41, s41, 0x1840000
    buffer_store_dwordx4 v[16:19], v5, s[28:31], s41 offen
L_prep_x2:
    s_mov_b32 s4, s8
    s_mov_b32 s5, s9
    s_mov_b32 s6, 1835008
    s_lshl_b32 s42, s40, 4
    v_add_u32 v7, s42, v3
    v_lshlrev_b32 v11, 3, v7
    v_mul_u32_u24 v7, 896, v7
    v_lshlrev_b32 v8, 3, v4
    v_add_u32 v7, v7, v8
    s_mul_i32 s34, s40, 14336
    s_add_u32 s34, s34, 0x1400000
    v_mov_b32 v60, 0
    v_mov_b32 v61, 0
    s_add_u32 s44, s3, 0
    s_cmp_ge_u32 s44, 14
    s_cbranch_scc1 L_prep_xld_1
    s_lshl_b32 s45, s44, 6
    buffer_load_dwordx2 v[32:33], v7, s[4:7], s45 offen
    buffer_load_dwordx2 v[34:35], v7, s[4:7], s45 offen offset:32
L_prep_xld_1:
    s_add_u32 s44, s3, 4
    s_cmp_ge_u32 s44, 14
    s_cbranch_scc1 L_prep_xld_2
    s_lshl_b32 s45, s44, 6
    buffer_load_dwordx2 v[36:37], v7, s[4:7], s45 offen
    buffer_load_dwordx2 v[38:39], v7, s[4:7], s45 offen offset:32
L_prep_xld_2:
    s_add_u32 s44, s3, 8
    s_cmp_ge_u32 s44, 14
    s_cbranch_scc1 L_prep_xld_3
    s_lshl_b32 s45, s44, 6
    buffer_load_dwordx2 v[40:41], v7, s[4:7], s45 offen
    buffer_load_dwordx2 v[42:43], v7, s[4:7], s45 offen offset:32
L_prep_xld_3:
    s_add_u32 s44, s3, 12
    s_cmp_ge_u32 s44, 14
    s_cbranch_scc1 L_prep_xld_4
    s_lshl_b32 s45, s44, 6
    buffer_load_dwordx2 v[44:45], v7, s[4:7], s45 offen
    buffer_load_dwordx2 v[46:47], v7, s[4:7], s45 offen offset:32
L_prep_xld_4:
    s_waitcnt vmcnt(0)
    s_add_u32 s44, s3, 0
    s_cmp_ge_u32 s44, 14
    s_cbranch_scc1 L_prep_xst_5
    s_lshl_b32 s45, s44, 10
    s_add_u32 s45, s45, s34
    buffer_store_dwordx4 v[32:35], v5, s[28:31], s45 offen
    v_dot2c_f32_bf16 v60, s39, v32
    v_dot2c_f32_bf16 v61, v32, v32
    v_dot2c_f32_bf16 v60, s39, v33
    v_dot2c_f32_bf16 v61, v33, v33
    v_dot2c_f32_bf16 v60, s39, v34
    v_dot2c_f32_bf16 v61, v34, v34
    v_dot2c_f32_bf16 v60, s39, v35
    v_dot2c_f32_bf16 v61, v35, v35
L_prep_xst_5:
    s_add_u32 s44, s3, 4
    s_cmp_ge_u32 s44, 14
    s_cbranch_scc1 L_prep_xst_6
    s_lshl_b32 s45, s44, 10
    s_add_u32 s45, s45, s34
    buffer_store_dwordx4 v[36:39], v5, s[28:31], s45 offen
    v_dot2c_f32_bf16 v60, s39, v36
    v_dot2c_f32_bf16 v61, v36, v36
    v_dot2c_f32_bf16 v60, s39, v37
    v_dot2c_f32_bf16 v61, v37, v37
    v_dot2c_f32_bf16 v60, s39, v38
    v_dot2c_f32_bf16 v61, v38, v38
    v_dot2c_f32_bf16 v60, s39, v39
    v_dot2c_f32_bf16 v61, v39, v39
L_prep_xst_6:
    s_add_u32 s44, s3, 8
    s_cmp_ge_u32 s44, 14
    s_cbranch_scc1 L_prep_xst_7
    s_lshl_b32 s45, s44, 10
    s_add_u32 s45, s45, s34
    buffer_store_dwordx4 v[40:43], v5, s[28:31], s45 offen
    v_dot2c_f32_bf16 v60, s39, v40
    v_dot2c_f32_bf16 v61, v40, v40
    v_dot2c_f32_bf16 v60, s39, v41
    v_dot2c_f32_bf16 v61, v41, v41
    v_dot2c_f32_bf16 v60, s39, v42
    v_dot2c_f32_bf16 v61, v42, v42
    v_dot2c_f32_bf16 v60, s39, v43
    v_dot2c_f32_bf16 v61, v43, v43
L_prep_xst_7:
    s_add_u32 s44, s3, 12
    s_cmp_ge_u32 s44, 14
    s_cbranch_scc1 L_prep_xst_8
    s_lshl_b32 s45, s44, 10
    s_add_u32 s45, s45, s34
    buffer_store_dwordx4 v[44:47], v5, s[28:31], s45 offen
    v_dot2c_f32_bf16 v60, s39, v44
    v_dot2c_f32_bf16 v61, v44, v44
    v_dot2c_f32_bf16 v60, s39, v45
    v_dot2c_f32_bf16 v61, v45, v45
    v_dot2c_f32_bf16 v60, s39, v46
    v_dot2c_f32_bf16 v61, v46, v46
    v_dot2c_f32_bf16 v60, s39, v47
    v_dot2c_f32_bf16 v61, v47, v47
L_prep_xst_8:
    s_nop 3
    v_mov_b32 v62, v60
    v_mov_b32 v63, v61
    s_nop 1
    v_permlane16_swap_b32 v60, v62
    v_permlane16_swap_b32 v61, v63
    v_add_f32 v60, v60, v62
    v_add_f32 v61, v61, v63
    v_mov_b32 v62, v60
    v_mov_b32 v63, v61
    s_nop 1
    v_permlane32_swap_b32 v60, v62
    v_permlane32_swap_b32 v61, v63
    v_add_f32 v60, v60, v62
    v_add_f32 v61, v61, v63
    s_lshl_b32 s45, s3, 14
    s_add_u32 s45, s45, 0x1800000
    buffer_store_dwordx2 v[60:61], v11, s[28:31], s45 offen
    s_cmp_ge_u32 s3, 3
    s_cbranch_scc1 L_prep_end
    v_mov_b32 v62, 0
    v_mov_b32 v63, 0
    s_add_u32 s45, s45, 0x10000
    buffer_store_dwordx2 v[62:63], v11, s[28:31], s45 offen
L_prep_end:
L_prep_end2:
    s_endpgm
.globl mega_kernel
.p2align 8
.type mega_kernel,@function
mega_kernel:
    s_cmp_ge_u32 s2, 256
    s_cbranch_scc1 L_mega_end
    s_load_dwordx2 s[4:5], s[0:1], 72
    s_mov_b32 s6, 0x6000000
    s_mov_b32 s7, 0x20000
    s_load_dwordx2 s[32:33], s[0:1], 56
    s_mov_b32 s34, 1835008
    s_mov_b32 s35, 0x20000
    v_lshrrev_b32 v1, 6, v0
    v_and_b32 v2, 63, v0
    v_and_b32 v3, 15, v0
    v_bfe_u32 v4, v0, 4, 2
    v_readfirstlane_b32 s3, v1
    v_lshlrev_b32 v5, 4, v2
    s_and_b32 s8, s2, 7
    s_lshr_b32 s9, s2, 3
    s_lshl_b32 s36, s8, 1
    s_lshr_b32 s10, s9, 4
    s_add_u32 s36, s36, s10
    s_and_b32 s37, s9, 15
    s_mov_b32 s38, 0x3b124925
    s_mov_b32 s39, 0x3727c5ac
    s_mov_b32 s40, 0x3f803f80
    s_waitcnt lgkmcnt(0)
    s_add_u32 s52, s4, 0x1400000
    s_addc_u32 s53, s5, 0
    s_mov_b32 s54, 0x3000000
    s_mov_b32 s55, 0x20000
    s_mov_b32 s51, 0
L_layer:
    s_lshl_b32 s12, s36, 3
    s_lshl_b32 s13, s3, 1
    s_add_u32 s12, s12, s13
    s_mul_i32 s14, s12, 14336
    s_add_u32 s14, s14, 0x0
    s_add_u32 s15, s14, 14336
    s_mul_i32 s16, s37, 86016
    s_add_u32 s16, s16, 0x800000
    s_mul_i32 s17, s3, 3072
    s_add_u32 s16, s16, s17
    v_add_u32 v8, 61440, v5
    s_mul_i32 s25, s37, 384
    s_add_u32 s25, s25, 0x1100000
    v_lshlrev_b32 v10, 4, v4
    v_lshlrev_b32 v11, 2, v3
    buffer_load_dwordx4 v[228:231], v10, s[4:7], s25 offen offset:0
    buffer_load_dwordx4 v[232:235], v10, s[4:7], s25 offen offset:64
    buffer_load_dwordx4 v[236:239], v10, s[4:7], s25 offen offset:128
    buffer_load_dwordx4 v[240:243], v10, s[4:7], s25 offen offset:192
    buffer_load_dword v252, v11, s[4:7], s25 offen offset:256
    buffer_load_dword v253, v11, s[4:7], s25 offen offset:320
    s_add_u32 s25, s25, 0x8000
    buffer_load_dwordx4 v[128:131], v10, s[4:7], s25 offen offset:0
    buffer_load_dwordx4 v[132:135], v10, s[4:7], s25 offen offset:64
    buffer_load_dwordx4 v[136:139], v10, s[4:7], s25 offen offset:128
    buffer_load_dwordx4 v[140:143], v10, s[4:7], s25 offen offset:192
    buffer_load_dword v144, v11, s[4:7], s25 offen offset:256
    buffer_load_dword v145, v11, s[4:7], s25 offen offset:320
    s_add_u32 s25, s25, 0x8000
    buffer_load_dwordx4 v[148:151], v10, s[4:7], s25 offen offset:0
    buffer_load_dwordx4 v[152:155], v10, s[4:7], s25 offen offset:64
    buffer_load_dwordx4 v[156:159], v10, s[4:7], s25 offen offset:128
    buffer_load_dwordx4 v[160:163], v10, s[4:7], s25 offen offset:192
    buffer_load_dword v164, v11, s[4:7], s25 offen offset:256
    buffer_load_dword v165, v11, s[4:7], s25 offen offset:320
    s_add_u32 s25, s25, 0x8000
    buffer_load_dwordx4 v[168:171], v10, s[4:7], s25 offen offset:0
    buffer_load_dwordx4 v[172:175], v10, s[4:7], s25 offen offset:64
    buffer_load_dwordx4 v[176:179], v10, s[4:7], s25 offen offset:128
    buffer_load_dwordx4 v[180:183], v10, s[4:7], s25 offen offset:192
    buffer_load_dword v184, v11, s[4:7], s25 offen offset:256
    buffer_load_dword v185, v11, s[4:7], s25 offen offset:320
    s_add_u32 s25, s25, 0x8000
    s_add_u32 s18, s17, 0
    s_mov_b32 m0, s18
    s_add_u32 s19, s16, 0
    buffer_load_dwordx4 v5, s[4:7], s19 offen offset:0 lds
    buffer_load_dwordx4 v5, s[4:7], s19 offen offset:1024 lds
    buffer_load_dwordx4 v5, s[4:7], s19 offen offset:2048 lds
    s_add_u32 s18, s17, 12288
    s_mov_b32 m0, s18
    s_add_u32 s19, s16, 12288
    buffer_load_dwordx4 v5, s[4:7], s19 offen offset:0 lds
    buffer_load_dwordx4 v5, s[4:7], s19 offen offset:1024 lds
    buffer_load_dwordx4 v5, s[4:7], s19 offen offset:2048 lds
    s_add_u32 s18, s17, 24576
    s_mov_b32 m0, s18
    s_add_u32 s19, s16, 24576
    buffer_load_dwordx4 v5, s[4:7], s19 offen offset:0 lds
    buffer_load_dwordx4 v5, s[4:7], s19 offen offset:1024 lds
    buffer_load_dwordx4 v5, s[4:7], s19 offen offset:2048 lds
    s_add_u32 s18, s17, 36864
    s_mov_b32 m0, s18
    s_add_u32 s19, s16, 36864
    buffer_load_dwordx4 v5, s[4:7], s19 offen offset:0 lds
    buffer_load_dwordx4 v5, s[4:7], s19 offen offset:1024 lds
    buffer_load_dwordx4 v5, s[4:7], s19 offen offset:2048 lds
    s_add_u32 s18, s17, 49152
    s_mov_b32 m0, s18
    s_add_u32 s19, s16, 49152
    buffer_load_dwordx4 v5, s[4:7], s19 offen offset:0 lds
    buffer_load_dwordx4 v5, s[4:7], s19 offen offset:1024 lds
    buffer_load_dwordx4 v5, s[4:7], s19 offen offset:2048 lds
    s_add_u32 s18, s17, 61440
    s_mov_b32 m0, s18
    s_add_u32 s19, s16, 61440
    buffer_load_dwordx4 v5, s[4:7], s19 offen offset:0 lds
    buffer_load_dwordx4 v5, s[4:7], s19 offen offset:1024 lds
    buffer_load_dwordx4 v5, s[4:7], s19 offen offset:2048 lds
    s_add_u32 s18, s17, 73728
    s_mov_b32 m0, s18
    s_add_u32 s19, s16, 73728
    buffer_load_dwordx4 v5, s[4:7], s19 offen offset:0 lds
    buffer_load_dwordx4 v5, s[4:7], s19 offen offset:1024 lds
    buffer_load_dwordx4 v5, s[4:7], s19 offen offset:2048 lds
    s_cmp_eq_u32 s51, 0
    s_cbranch_scc1 L_qkv_nowait
    s_lshl_b32 s41, s36, 9
    s_add_u32 s41, s41, 0x440180
    s_cmp_lg_u32 s3, 0
    s_cbranch_scc1 L_wdone_9
    s_mov_b32 s42, 0x40000
    v_mov_b32 v255, 0
L_wloop_10:
    buffer_load_dword v254, v255, s[52:55], s41 offen sc0 sc1
    s_waitcnt vmcnt(0)
    v_readfirstlane_b32 s43, v254
    s_cmp_ge_u32 s43, 14
    s_cbranch_scc1 L_wdone_9
    s_sub_u32 s42, s42, 1
    s_cmp_eq_u32 s42, 0
    s_cbranch_scc1 L_wdone_9
    s_sleep 1
    s_branch L_wloop_10
L_wdone_9:
    s_barrier
L_qkv_nowait:
    v_lshlrev_b32 v6, 14, v4
    v_lshl_add_u32 v6, v3, 3, v6
    v_add_u32 v7, 0x10000, v6
    v_cmp_gt_u32 vcc, 3, v4
    v_mov_b32 v244, 0x40000000
    s_lshl_b32 s30, s12, 7
    s_add_u32 s30, s30, 0x400000
    v_cndmask_b32 v7, v244, v7, vcc
    buffer_load_dwordx2 v[244:245], v6, s[52:55], s30 offen offset:0
    buffer_load_dwordx2 v[246:247], v7, s[52:55], s30 offen offset:0
    buffer_load_dwordx2 v[248:249], v6, s[52:55], s30 offen offset:128
    buffer_load_dwordx2 v[250:251], v7, s[52:55], s30 offen offset:128
    s_add_u32 s23, s14, 0
    s_add_u32 s24, s15, 0
    buffer_load_dwordx4 v[16:19], v5, s[52:55], s23 offen offset:0
    buffer_load_dwordx4 v[72:75], v5, s[52:55], s24 offen offset:0
    buffer_load_dwordx4 v[20:23], v5, s[52:55], s23 offen offset:1024
    buffer_load_dwordx4 v[76:79], v5, s[52:55], s24 offen offset:1024
    s_add_u32 s23, s14, 2048
    s_add_u32 s24, s15, 2048
    buffer_load_dwordx4 v[24:27], v5, s[52:55], s23 offen offset:0
    buffer_load_dwordx4 v[80:83], v5, s[52:55], s24 offen offset:0
    buffer_load_dwordx4 v[28:31], v5, s[52:55], s23 offen offset:1024
    buffer_load_dwordx4 v[84:87], v5, s[52:55], s24 offen offset:1024
    s_add_u32 s23, s14, 4096
    s_add_u32 s24, s15, 4096
    buffer_load_dwordx4 v[32:35], v5, s[52:55], s23 offen offset:0
    buffer_load_dwordx4 v[88:91], v5, s[52:55], s24 offen offset:0
    buffer_load_dwordx4 v[36:39], v5, s[52:55], s23 offen offset:1024
    buffer_load_dwordx4 v[92:95], v5, s[52:55], s24 offen offset:1024
    s_add_u32 s23, s14, 6144
    s_add_u32 s24, s15, 6144
    buffer_load_dwordx4 v[40:43], v5, s[52:55], s23 offen offset:0
    buffer_load_dwordx4 v[96:99], v5, s[52:55], s24 offen offset:0
    buffer_load_dwordx4 v[44:47], v5, s[52:55], s23 offen offset:1024
    buffer_load_dwordx4 v[100:103], v5, s[52:55], s24 offen offset:1024
    s_waitcnt vmcnt(16)
    v_add_f32 v224, v244, v246
    v_add_f32 v226, v245, v247
    v_add_f32 v225, v248, v250
    v_add_f32 v227, v249, v251
    v_mov_b32 v12, v224
    v_mov_b32 v13, v225
    v_mov_b32 v14, v226
    v_mov_b32 v15, v227
    v_permlane16_swap_b32 v224, v12
    v_permlane16_swap_b32 v225, v13
    v_permlane16_swap_b32 v226, v14
    v_permlane16_swap_b32 v227, v15
    v_add_f32 v224, v224, v12
    v_add_f32 v225, v225, v13
    v_add_f32 v226, v226, v14
    v_add_f32 v227, v227, v15
    v_mov_b32 v12, v224
    v_mov_b32 v13, v225
    v_mov_b32 v14, v226
    v_mov_b32 v15, v227
    v_permlane32_swap_b32 v224, v12
    v_permlane32_swap_b32 v225, v13
    v_permlane32_swap_b32 v226, v14
    v_permlane32_swap_b32 v227, v15
    v_add_f32 v224, v224, v12
    v_add_f32 v225, v225, v13
    v_add_f32 v226, v226, v14
    v_add_f32 v227, v227, v15
    v_mul_f32 v224, s38, v224
    v_mul_f32 v226, s38, v226
    v_fma_f32 v226, -v224, v224, v226
    v_max_f32 v226, 0, v226
    v_cvt_pk_bf16_f32 v12, v224, v226
    v_lshlrev_b32 v224, 16, v12
    v_xor_b32 v224, 0x80000000, v224
    v_and_b32 v226, 0xffff0000, v12
    v_add_f32 v226, s39, v226
    v_cvt_pk_bf16_f32 v226, v226, v226
    v_and_b32 v226, 0xffff0000, v226
    v_sqrt_f32 v226, v226
    s_nop 0
    v_cvt_pk_bf16_f32 v226, v226, v226
    v_and_b32 v226, 0xffff0000, v226
    v_rcp_f32 v226, v226
    s_nop 0
    v_mul_f32 v225, s38, v225
    v_mul_f32 v227, s38, v227
    v_fma_f32 v227, -v225, v225, v227
    v_max_f32 v227, 0, v227
    v_cvt_pk_bf16_f32 v12, v225, v227
    v_lshlrev_b32 v225, 16, v12
    v_xor_b32 v225, 0x80000000, v225
    v_and_b32 v227, 0xffff0000, v12
    v_add_f32 v227, s39, v227
    v_cvt_pk_bf16_f32 v227, v227, v227
    v_and_b32 v227, 0xffff0000, v227
    v_sqrt_f32 v227, v227
    s_nop 0
    v_cvt_pk_bf16_f32 v227, v227, v227
    v_and_b32 v227, 0xffff0000, v227
    v_rcp_f32 v227, v227
    s_nop 0
    v_pk_add_f32 v[228:229], v[228:229], v[128:129]
    v_pk_add_f32 v[230:231], v[230:231], v[130:131]
    v_pk_add_f32 v[232:233], v[232:233], v[132:133]
    v_pk_add_f32 v[234:235], v[234:235], v[134:135]
    v_pk_add_f32 v[236:237], v[236:237], v[136:137]
    v_pk_add_f32 v[238:239], v[238:239], v[138:139]
    v_pk_add_f32 v[240:241], v[240:241], v[140:141]
    v_pk_add_f32 v[242:243], v[242:243], v[142:143]
    v_pk_add_f32 v[252:253], v[252:253], v[144:145]
    v_pk_add_f32 v[228:229], v[228:229], v[148:149]
    v_pk_add_f32 v[230:231], v[230:231], v[150:151]
    v_pk_add_f32 v[232:233], v[232:233], v[152:153]
    v_pk_add_f32 v[234:235], v[234:235], v[154:155]
    v_pk_add_f32 v[236:237], v[236:237], v[156:157]
    v_pk_add_f32 v[238:239], v[238:239], v[158:159]
    v_pk_add_f32 v[240:241], v[240:241], v[160:161]
    v_pk_add_f32 v[242:243], v[242:243], v[162:163]
    v_pk_add_f32 v[252:253], v[252:253], v[164:165]
    v_pk_add_f32 v[228:229], v[228:229], v[168:169]
    v_pk_add_f32 v[230:231], v[230:231], v[170:171]
    v_pk_add_f32 v[232:233], v[232:233], v[172:173]
    v_pk_add_f32 v[234:235], v[234:235], v[174:175]
    v_pk_add_f32 v[236:237], v[236:237], v[176:177]
    v_pk_add_f32 v[238:239], v[238:239], v[178:179]
    v_pk_add_f32 v[240:241], v[240:241], v[180:181]
    v_pk_add_f32 v[242:243], v[242:243], v[182:183]
    v_pk_add_f32 v[252:253], v[252:253], v[184:185]
    s_waitcnt vmcnt(12)
    s_barrier
    ds_read_b128 v[176:179], v5 offset:0
    ds_read_b128 v[180:183], v5 offset:1024
    ds_read_b128 v[184:187], v5 offset:2048
    ds_read_b128 v[188:191], v5 offset:3072
    ds_read_b128 v[192:195], v5 offset:4096
    ds_read_b128 v[196:199], v5 offset:5120
    s_add_u32 s23, s14, 8192
    s_add_u32 s24, s15, 8192
    buffer_load_dwordx4 v[48:51], v5, s[52:55], s23 offen offset:0
    s_waitcnt lgkmcnt(5)
    v_mfma_f32_16x16x32_bf16 v[128:131], v[176:179], v[16:19], 0
    buffer_load_dwordx4 v[104:107], v5, s[52:55], s24 offen offset:0
    s_waitcnt lgkmcnt(4)
    v_mfma_f32_16x16x32_bf16 v[132:135], v[180:183], v[16:19], 0
    s_waitcnt lgkmcnt(3)
    v_mfma_f32_16x16x32_bf16 v[136:139], v[184:187], v[16:19], 0
    buffer_load_dwordx4 v[52:55], v5, s[52:55], s23 offen offset:1024
    s_waitcnt lgkmcnt(2)
    v_mfma_f32_16x16x32_bf16 v[140:143], v[188:191], v[16:19], 0
    buffer_load_dwordx4 v[108:111], v5, s[52:55], s24 offen offset:1024
    s_waitcnt lgkmcnt(1)
    v_mfma_f32_16x16x32_bf16 v[144:147], v[16:19], v[192:195], 0
    s_waitcnt lgkmcnt(0)
    v_mfma_f32_16x16x32_bf16 v[148:151], v[16:19], v[196:199], 0
    ds_read_b128 v[200:203], v5 offset:6144
    v_mfma_f32_16x16x32_bf16 v[152:155], v[176:179], v[72:75], 0
    ds_read_b128 v[204:207], v5 offset:7168
    v_mfma_f32_16x16x32_bf16 v[156:159], v[180:183], v[72:75], 0
    ds_read_b128 v[208:211], v5 offset:8192
    v_mfma_f32_16x16x32_bf16 v[160:163], v[184:187], v[72:75], 0
    ds_read_b128 v[212:215], v5 offset:9216
    v_mfma_f32_16x16x32_bf16 v[164:167], v[188:191], v[72:75], 0
    ds_read_b128 v[216:219], v5 offset:10240
    v_mfma_f32_16x16x32_bf16 v[168:171], v[72:75], v[192:195], 0
    ds_read_b128 v[220:223], v5 offset:11264
    v_mfma_f32_16x16x32_bf16 v[172:175], v[72:75], v[196:199], 0
    s_waitcnt lgkmcnt(5)
    v_mfma_f32_16x16x32_bf16 v[128:131], v[200:203], v[20:23], v[128:131]
    s_waitcnt lgkmcnt(4)
    v_mfma_f32_16x16x32_bf16 v[132:135], v[204:207], v[20:23], v[132:135]
    s_waitcnt lgkmcnt(3)
    v_mfma_f32_16x16x32_bf16 v[136:139], v[208:211], v[20:23], v[136:139]
    s_waitcnt lgkmcnt(2)
    v_mfma_f32_16x16x32_bf16 v[140:143], v[212:215], v[20:23], v[140:143]
    s_waitcnt lgkmcnt(1)
    v_mfma_f32_16x16x32_bf16 v[144:147], v[20:23], v[216:219], v[144:147]
    s_waitcnt lgkmcnt(0)
    v_mfma_f32_16x16x32_bf16 v[148:151], v[20:23], v[220:223], v[148:151]
    ds_read_b128 v[176:179], v5 offset:12288
    v_mfma_f32_16x16x32_bf16 v[152:155], v[200:203], v[76:79], v[152:155]
    ds_read_b128 v[180:183], v5 offset:13312
    v_mfma_f32_16x16x32_bf16 v[156:159], v[204:207], v[76:79], v[156:159]
    ds_read_b128 v[184:187], v5 offset:14336
    v_mfma_f32_16x16x32_bf16 v[160:163], v[208:211], v[76:79], v[160:163]
    ds_read_b128 v[188:191], v5 offset:15360
    v_mfma_f32_16x16x32_bf16 v[164:167], v[212:215], v[76:79], v[164:167]
    ds_read_b128 v[192:195], v5 offset:16384
    v_mfma_f32_16x16x32_bf16 v[168:171], v[76:79], v[216:219], v[168:171]
    ds_read_b128 v[196:199], v5 offset:17408
    v_mfma_f32_16x16x32_bf16 v[172:175], v[76:79], v[220:223], v[172:175]
    s_waitcnt vmcnt(12)
    s_add_u32 s23, s14, 10240
    s_add_u32 s24, s15, 10240
    buffer_load_dwordx4 v[56:59], v5, s[52:55], s23 offen offset:0
    s_waitcnt lgkmcnt(5)
    v_mfma_f32_16x16x32_bf16 v[128:131], v[176:179], v[24:27], v[128:131]
    buffer_load_dwordx4 v[112:115], v5, s[52:55], s24 offen offset:0
    s_waitcnt lgkmcnt(4)
    v_mfma_f32_16x16x32_bf16 v[132:135], v[180:183], v[24:27], v[132:135]
    s_waitcnt lgkmcnt(3)
    v_mfma_f32_16x16x32_bf16 v[136:139], v[184:187], v[24:27], v[136:139]
    buffer_load_dwordx4 v[60:63], v5, s[52:55], s23 offen offset:1024
    s_waitcnt lgkmcnt(2)
    v_mfma_f32_16x16x32_bf16 v[140:143], v[188:191], v[24:27], v[140:143]
    buffer_load_dwordx4 v[116:119], v5, s[52:55], s24 offen offset:1024
    s_waitcnt lgkmcnt(1)
    v_mfma_f32_16x16x32_bf16 v[144:147], v[24:27], v[192:195], v[144:147]
    s_waitcnt lgkmcnt(0)
    v_mfma_f32_16x16x32_bf16 v[148:151], v[24:27], v[196:199], v[148:151]
    ds_read_b128 v[200:203], v5 offset:18432
    v_mfma_f32_16x16x32_bf16 v[152:155], v[176:179], v[80:83], v[152:155]
    ds_read_b128 v[204:207], v5 offset:19456
    v_mfma_f32_16x16x32_bf16 v[156:159], v[180:183], v[80:83], v[156:159]
    ds_read_b128 v[208:211], v5 offset:20480
    v_mfma_f32_16x16x32_bf16 v[160:163], v[184:187], v[80:83], v[160:163]
    ds_read_b128 v[212:215], v5 offset:21504
    v_mfma_f32_16x16x32_bf16 v[164:167], v[188:191], v[80:83], v[164:167]
    ds_read_b128 v[216:219], v5 offset:22528
    v_mfma_f32_16x16x32_bf16 v[168:171], v[80:83], v[192:195], v[168:171]
    ds_read_b128 v[220:223], v5 offset:23552
    v_mfma_f32_16x16x32_bf16 v[172:175], v[80:83], v[196:199], v[172:175]
    s_waitcnt lgkmcnt(5)
    v_mfma_f32_16x16x32_bf16 v[128:131], v[200:203], v[28:31], v[128:131]
    s_waitcnt lgkmcnt(4)
    v_mfma_f32_16x16x32_bf16 v[132:135], v[204:207], v[28:31], v[132:135]
    s_waitcnt lgkmcnt(3)
    v_mfma_f32_16x16x32_bf16 v[136:139], v[208:211], v[28:31], v[136:139]
    s_waitcnt lgkmcnt(2)
    v_mfma_f32_16x16x32_bf16 v[140:143], v[212:215], v[28:31], v[140:143]
    s_waitcnt lgkmcnt(1)
    v_mfma_f32_16x16x32_bf16 v[144:147], v[28:31], v[216:219], v[144:147]
    s_waitcnt lgkmcnt(0)
    v_mfma_f32_16x16x32_bf16 v[148:151], v[28:31], v[220:223], v[148:151]
    ds_read_b128 v[176:179], v5 offset:24576
    v_mfma_f32_16x16x32_bf16 v[152:155], v[200:203], v[84:87], v[152:155]
    ds_read_b128 v[180:183], v5 offset:25600
    v_mfma_f32_16x16x32_bf16 v[156:159], v[204:207], v[84:87], v[156:159]
    ds_read_b128 v[184:187], v5 offset:26624
    v_mfma_f32_16x16x32_bf16 v[160:163], v[208:211], v[84:87], v[160:163]
    ds_read_b128 v[188:191], v5 offset:27648
    v_mfma_f32_16x16x32_bf16 v[164:167], v[212:215], v[84:87], v[164:167]
    ds_read_b128 v[192:195], v5 offset:28672
    v_mfma_f32_16x16x32_bf16 v[168:171], v[84:87], v[216:219], v[168:171]
    ds_read_b128 v[196:199], v5 offset:29696
    v_mfma_f32_16x16x32_bf16 v[172:175], v[84:87], v[220:223], v[172:175]
    s_waitcnt vmcnt(12)
    s_add_u32 s23, s14, 12288
    s_add_u32 s24, s15, 12288
    buffer_load_dwordx4 v[64:67], v5, s[52:55], s23 offen offset:0
    s_waitcnt lgkmcnt(5)
    v_mfma_f32_16x16x32_bf16 v[128:131], v[176:179], v[32:35], v[128:131]
    buffer_load_dwordx4 v[120:123], v5, s[52:55], s24 offen offset:0
    s_waitcnt lgkmcnt(4)
    v_mfma_f32_16x16x32_bf16 v[132:135], v[180:183], v[32:35], v[132:135]
    s_waitcnt lgkmcnt(3)
    v_mfma_f32_16x16x32_bf16 v[136:139], v[184:187], v[32:35], v[136:139]
    buffer_load_dwordx4 v[68:71], v5, s[52:55], s23 offen offset:1024
    s_waitcnt lgkmcnt(2)
    v_mfma_f32_16x16x32_bf16 v[140:143], v[188:191], v[32:35], v[140:143]
    buffer_load_dwordx4 v[124:127], v5, s[52:55], s24 offen offset:1024
    s_waitcnt lgkmcnt(1)
    v_mfma_f32_16x16x32_bf16 v[144:147], v[32:35], v[192:195], v[144:147]
    s_waitcnt lgkmcnt(0)
    v_mfma_f32_16x16x32_bf16 v[148:151], v[32:35], v[196:199], v[148:151]
    ds_read_b128 v[200:203], v5 offset:30720
    v_mfma_f32_16x16x32_bf16 v[152:155], v[176:179], v[88:91], v[152:155]
    ds_read_b128 v[204:207], v5 offset:31744
    v_mfma_f32_16x16x32_bf16 v[156:159], v[180:183], v[88:91], v[156:159]
    ds_read_b128 v[208:211], v5 offset:32768
    v_mfma_f32_16x16x32_bf16 v[160:163], v[184:187], v[88:91], v[160:163]
    ds_read_b128 v[212:215], v5 offset:33792
    v_mfma_f32_16x16x32_bf16 v[164:167], v[188:191], v[88:91], v[164:167]
    ds_read_b128 v[216:219], v5 offset:34816
    v_mfma_f32_16x16x32_bf16 v[168:171], v[88:91], v[192:195], v[168:171]
    ds_read_b128 v[220:223], v5 offset:35840
    v_mfma_f32_16x16x32_bf16 v[172:175], v[88:91], v[196:199], v[172:175]
    s_waitcnt lgkmcnt(5)
    v_mfma_f32_16x16x32_bf16 v[128:131], v[200:203], v[36:39], v[128:131]
    s_waitcnt lgkmcnt(4)
    v_mfma_f32_16x16x32_bf16 v[132:135], v[204:207], v[36:39], v[132:135]
    s_waitcnt lgkmcnt(3)
    v_mfma_f32_16x16x32_bf16 v[136:139], v[208:211], v[36:39], v[136:139]
    s_waitcnt lgkmcnt(2)
    v_mfma_f32_16x16x32_bf16 v[140:143], v[212:215], v[36:39], v[140:143]
    s_waitcnt lgkmcnt(1)
    v_mfma_f32_16x16x32_bf16 v[144:147], v[36:39], v[216:219], v[144:147]
    s_waitcnt lgkmcnt(0)
    v_mfma_f32_16x16x32_bf16 v[148:151], v[36:39], v[220:223], v[148:151]
    ds_read_b128 v[176:179], v5 offset:36864
    v_mfma_f32_16x16x32_bf16 v[152:155], v[200:203], v[92:95], v[152:155]
    ds_read_b128 v[180:183], v5 offset:37888
    v_mfma_f32_16x16x32_bf16 v[156:159], v[204:207], v[92:95], v[156:159]
    ds_read_b128 v[184:187], v5 offset:38912
    v_mfma_f32_16x16x32_bf16 v[160:163], v[208:211], v[92:95], v[160:163]
    ds_read_b128 v[188:191], v5 offset:39936
    v_mfma_f32_16x16x32_bf16 v[164:167], v[212:215], v[92:95], v[164:167]
    ds_read_b128 v[192:195], v5 offset:40960
    v_mfma_f32_16x16x32_bf16 v[168:171], v[92:95], v[216:219], v[168:171]
    ds_read_b128 v[196:199], v5 offset:41984
    v_mfma_f32_16x16x32_bf16 v[172:175], v[92:95], v[220:223], v[172:175]
    s_waitcnt vmcnt(12)
    s_waitcnt lgkmcnt(5)
    v_mfma_f32_16x16x32_bf16 v[128:131], v[176:179], v[40:43], v[128:131]
    s_waitcnt lgkmcnt(4)
    v_mfma_f32_16x16x32_bf16 v[132:135], v[180:183], v[40:43], v[132:135]
    s_waitcnt lgkmcnt(3)
    v_mfma_f32_16x16x32_bf16 v[136:139], v[184:187], v[40:43], v[136:139]
    s_waitcnt lgkmcnt(2)
    v_mfma_f32_16x16x32_bf16 v[140:143], v[188:191], v[40:43], v[140:143]
    s_waitcnt lgkmcnt(1)
    v_mfma_f32_16x16x32_bf16 v[144:147], v[40:43], v[192:195], v[144:147]
    s_waitcnt lgkmcnt(0)
    v_mfma_f32_16x16x32_bf16 v[148:151], v[40:43], v[196:199], v[148:151]
    ds_read_b128 v[200:203], v5 offset:43008
    v_mfma_f32_16x16x32_bf16 v[152:155], v[176:179], v[96:99], v[152:155]
    ds_read_b128 v[204:207], v5 offset:44032
    v_mfma_f32_16x16x32_bf16 v[156:159], v[180:183], v[96:99], v[156:159]
    ds_read_b128 v[208:211], v5 offset:45056
    v_mfma_f32_16x16x32_bf16 v[160:163], v[184:187], v[96:99], v[160:163]
    ds_read_b128 v[212:215], v5 offset:46080
    v_mfma_f32_16x16x32_bf16 v[164:167], v[188:191], v[96:99], v[164:167]
    ds_read_b128 v[216:219], v5 offset:47104
    v_mfma_f32_16x16x32_bf16 v[168:171], v[96:99], v[192:195], v[168:171]
    ds_read_b128 v[220:223], v5 offset:48128
    v_mfma_f32_16x16x32_bf16 v[172:175], v[96:99], v[196:199], v[172:175]
    s_waitcnt lgkmcnt(5)
    v_mfma_f32_16x16x32_bf16 v[128:131], v[200:203], v[44:47], v[128:131]
    s_waitcnt lgkmcnt(4)
    v_mfma_f32_16x16x32_bf16 v[132:135], v[204:207], v[44:47], v[132:135]
    s_waitcnt lgkmcnt(3)
    v_mfma_f32_16x16x32_bf16 v[136:139], v[208:211], v[44:47], v[136:139]
    s_waitcnt lgkmcnt(2)
    v_mfma_f32_16x16x32_bf16 v[140:143], v[212:215], v[44:47], v[140:143]
    s_waitcnt lgkmcnt(1)
    v_mfma_f32_16x16x32_bf16 v[144:147], v[44:47], v[216:219], v[144:147]
    s_waitcnt lgkmcnt(0)
    v_mfma_f32_16x16x32_bf16 v[148:151], v[44:47], v[220:223], v[148:151]
    ds_read_b128 v[176:179], v5 offset:49152
    v_mfma_f32_16x16x32_bf16 v[152:155], v[200:203], v[100:103], v[152:155]
    ds_read_b128 v[180:183], v5 offset:50176
    v_mfma_f32_16x16x32_bf16 v[156:159], v[204:207], v[100:103], v[156:159]
    ds_read_b128 v[184:187], v5 offset:51200
    v_mfma_f32_16x16x32_bf16 v[160:163], v[208:211], v[100:103], v[160:163]
    ds_read_b128 v[188:191], v5 offset:52224
    v_mfma_f32_16x16x32_bf16 v[164:167], v[212:215], v[100:103], v[164:167]
    ds_read_b128 v[192:195], v5 offset:53248
    v_mfma_f32_16x16x32_bf16 v[168:171], v[100:103], v[216:219], v[168:171]
    ds_read_b128 v[196:199], v5 offset:54272
    v_mfma_f32_16x16x32_bf16 v[172:175], v[100:103], v[220:223], v[172:175]
    s_waitcnt vmcnt(8)
    s_waitcnt lgkmcnt(5)
    v_mfma_f32_16x16x32_bf16 v[128:131], v[176:179], v[48:51], v[128:131]
    s_waitcnt lgkmcnt(4)
    v_mfma_f32_16x16x32_bf16 v[132:135], v[180:183], v[48:51], v[132:135]
    s_waitcnt lgkmcnt(3)
    v_mfma_f32_16x16x32_bf16 v[136:139], v[184:187], v[48:51], v[136:139]
    s_waitcnt lgkmcnt(2)
    v_mfma_f32_16x16x32_bf16 v[140:143], v[188:191], v[48:51], v[140:143]
    s_waitcnt lgkmcnt(1)
    v_mfma_f32_16x16x32_bf16 v[144:147], v[48:51], v[192:195], v[144:147]
    s_waitcnt lgkmcnt(0)
    v_mfma_f32_16x16x32_bf16 v[148:151], v[48:51], v[196:199], v[148:151]
    ds_read_b128 v[200:203], v5 offset:55296
    v_mfma_f32_16x16x32_bf16 v[152:155], v[176:179], v[104:107], v[152:155]
    ds_read_b128 v[204:207], v5 offset:56320
    v_mfma_f32_16x16x32_bf16 v[156:159], v[180:183], v[104:107], v[156:159]
    ds_read_b128 v[208:211], v5 offset:57344
    v_mfma_f32_16x16x32_bf16 v[160:163], v[184:187], v[104:107], v[160:163]
    ds_read_b128 v[212:215], v5 offset:58368
    v_mfma_f32_16x16x32_bf16 v[164:167], v[188:191], v[104:107], v[164:167]
    ds_read_b128 v[216:219], v5 offset:59392
    v_mfma_f32_16x16x32_bf16 v[168:171], v[104:107], v[192:195], v[168:171]
    ds_read_b128 v[220:223], v5 offset:60416
    v_mfma_f32_16x16x32_bf16 v[172:175], v[104:107], v[196:199], v[172:175]
    s_waitcnt lgkmcnt(5)
    v_mfma_f32_16x16x32_bf16 v[128:131], v[200:203], v[52:55], v[128:131]
    s_waitcnt lgkmcnt(4)
    v_mfma_f32_16x16x32_bf16 v[132:135], v[204:207], v[52:55], v[132:135]
    s_waitcnt lgkmcnt(3)
    v_mfma_f32_16x16x32_bf16 v[136:139], v[208:211], v[52:55], v[136:139]
    s_waitcnt lgkmcnt(2)
    v_mfma_f32_16x16x32_bf16 v[140:143], v[212:215], v[52:55], v[140:143]
    s_waitcnt lgkmcnt(1)
    v_mfma_f32_16x16x32_bf16 v[144:147], v[52:55], v[216:219], v[144:147]
    s_waitcnt lgkmcnt(0)
    v_mfma_f32_16x16x32_bf16 v[148:151], v[52:55], v[220:223], v[148:151]
    ds_read_b128 v[176:179], v8 offset:0
    v_mfma_f32_16x16x32_bf16 v[152:155], v[200:203], v[108:111], v[152:155]
    ds_read_b128 v[180:183], v8 offset:1024
    v_mfma_f32_16x16x32_bf16 v[156:159], v[204:207], v[108:111], v[156:159]
    ds_read_b128 v[184:187], v8 offset:2048
    v_mfma_f32_16x16x32_bf16 v[160:163], v[208:211], v[108:111], v[160:163]
    ds_read_b128 v[188:191], v8 offset:3072
    v_mfma_f32_16x16x32_bf16 v[164:167], v[212:215], v[108:111], v[164:167]
    ds_read_b128 v[192:195], v8 offset:4096
    v_mfma_f32_16x16x32_bf16 v[168:171], v[108:111], v[216:219], v[168:171]
    ds_read_b128 v[196:199], v8 offset:5120
    v_mfma_f32_16x16x32_bf16 v[172:175], v[108:111], v[220:223], v[172:175]
    s_waitcnt vmcnt(4)
    s_waitcnt lgkmcnt(5)
    v_mfma_f32_16x16x32_bf16 v[128:131], v[176:179], v[56:59], v[128:131]
    s_waitcnt lgkmcnt(4)
    v_mfma_f32_16x16x32_bf16 v[132:135], v[180:183], v[56:59], v[132:135]
    s_waitcnt lgkmcnt(3)
    v_mfma_f32_16x16x32_bf16 v[136:139], v[184:187], v[56:59], v[136:139]
    s_waitcnt lgkmcnt(2)
    v_mfma_f32_16x16x32_bf16 v[140:143], v[188:191], v[56:59], v[140:143]
    s_waitcnt lgkmcnt(1)
    v_mfma_f32_16x16x32_bf16 v[144:147], v[56:59], v[192:195], v[144:147]
    s_waitcnt lgkmcnt(0)
    v_mfma_f32_16x16x32_bf16 v[148:151], v[56:59], v[196:199], v[148:151]
    ds_read_b128 v[200:203], v8 offset:6144
    v_mfma_f32_16x16x32_bf16 v[152:155], v[176:179], v[112:115], v[152:155]
    ds_read_b128 v[204:207], v8 offset:7168
    v_mfma_f32_16x16x32_bf16 v[156:159], v[180:183], v[112:115], v[156:159]
    ds_read_b128 v[208:211], v8 offset:8192
    v_mfma_f32_16x16x32_bf16 v[160:163], v[184:187], v[112:115], v[160:163]
    ds_read_b128 v[212:215], v8 offset:9216
    v_mfma_f32_16x16x32_bf16 v[164:167], v[188:191], v[112:115], v[164:167]
    ds_read_b128 v[216:219], v8 offset:10240
    v_mfma_f32_16x16x32_bf16 v[168:171], v[112:115], v[192:195], v[168:171]
    ds_read_b128 v[220:223], v8 offset:11264
    v_mfma_f32_16x16x32_bf16 v[172:175], v[112:115], v[196:199], v[172:175]
    s_waitcnt lgkmcnt(5)
    v_mfma_f32_16x16x32_bf16 v[128:131], v[200:203], v[60:63], v[128:131]
    s_waitcnt lgkmcnt(4)
    v_mfma_f32_16x16x32_bf16 v[132:135], v[204:207], v[60:63], v[132:135]
    s_waitcnt lgkmcnt(3)
    v_mfma_f32_16x16x32_bf16 v[136:139], v[208:211], v[60:63], v[136:139]
    s_waitcnt lgkmcnt(2)
    v_mfma_f32_16x16x32_bf16 v[140:143], v[212:215], v[60:63], v[140:143]
    s_waitcnt lgkmcnt(1)
    v_mfma_f32_16x16x32_bf16 v[144:147], v[60:63], v[216:219], v[144:147]
    s_waitcnt lgkmcnt(0)
    v_mfma_f32_16x16x32_bf16 v[148:151], v[60:63], v[220:223], v[148:151]
    ds_read_b128 v[176:179], v8 offset:12288
    v_mfma_f32_16x16x32_bf16 v[152:155], v[200:203], v[116:119], v[152:155]
    ds_read_b128 v[180:183], v8 offset:13312
    v_mfma_f32_16x16x32_bf16 v[156:159], v[204:207], v[116:119], v[156:159]
    ds_read_b128 v[184:187], v8 offset:14336
    v_mfma_f32_16x16x32_bf16 v[160:163], v[208:211], v[116:119], v[160:163]
    ds_read_b128 v[188:191], v8 offset:15360
    v_mfma_f32_16x16x32_bf16 v[164:167], v[212:215], v[116:119], v[164:167]
    ds_read_b128 v[192:195], v8 offset:16384
    v_mfma_f32_16x16x32_bf16 v[168:171], v[116:119], v[216:219], v[168:171]
    ds_read_b128 v[196:199], v8 offset:17408
    v_mfma_f32_16x16x32_bf16 v[172:175], v[116:119], v[220:223], v[172:175]
    s_waitcnt vmcnt(0)
    s_waitcnt lgkmcnt(5)
    v_mfma_f32_16x16x32_bf16 v[128:131], v[176:179], v[64:67], v[128:131]
    s_waitcnt lgkmcnt(4)
    v_mfma_f32_16x16x32_bf16 v[132:135], v[180:183], v[64:67], v[132:135]
    s_waitcnt lgkmcnt(3)
    v_mfma_f32_16x16x32_bf16 v[136:139], v[184:187], v[64:67], v[136:139]
    s_waitcnt lgkmcnt(2)
    v_mfma_f32_16x16x32_bf16 v[140:143], v[188:191], v[64:67], v[140:143]
    s_waitcnt lgkmcnt(1)
    v_mfma_f32_16x16x32_bf16 v[144:147], v[64:67], v[192:195], v[144:147]
    s_waitcnt lgkmcnt(0)
    v_mfma_f32_16x16x32_bf16 v[148:151], v[64:67], v[196:199], v[148:151]
    ds_read_b128 v[200:203], v8 offset:18432
    v_mfma_f32_16x16x32_bf16 v[152:155], v[176:179], v[120:123], v[152:155]
    ds_read_b128 v[204:207], v8 offset:19456
    v_mfma_f32_16x16x32_bf16 v[156:159], v[180:183], v[120:123], v[156:159]
    ds_read_b128 v[208:211], v8 offset:20480
    v_mfma_f32_16x16x32_bf16 v[160:163], v[184:187], v[120:123], v[160:163]
    ds_read_b128 v[212:215], v8 offset:21504
    v_mfma_f32_16x16x32_bf16 v[164:167], v[188:191], v[120:123], v[164:167]
    ds_read_b128 v[216:219], v8 offset:22528
    v_mfma_f32_16x16x32_bf16 v[168:171], v[120:123], v[192:195], v[168:171]
    ds_read_b128 v[220:223], v8 offset:23552
    v_mfma_f32_16x16x32_bf16 v[172:175], v[120:123], v[196:199], v[172:175]
    s_waitcnt lgkmcnt(5)
    v_mfma_f32_16x16x32_bf16 v[128:131], v[200:203], v[68:71], v[128:131]
    s_waitcnt lgkmcnt(4)
    v_mfma_f32_16x16x32_bf16 v[132:135], v[204:207], v[68:71], v[132:135]
    s_waitcnt lgkmcnt(3)
    v_mfma_f32_16x16x32_bf16 v[136:139], v[208:211], v[68:71], v[136:139]
    s_waitcnt lgkmcnt(2)
    v_mfma_f32_16x16x32_bf16 v[140:143], v[212:215], v[68:71], v[140:143]
    s_waitcnt lgkmcnt(1)
    v_mfma_f32_16x16x32_bf16 v[144:147], v[68:71], v[216:219], v[144:147]
    s_waitcnt lgkmcnt(0)
    v_mfma_f32_16x16x32_bf16 v[148:151], v[68:71], v[220:223], v[148:151]
    v_mfma_f32_16x16x32_bf16 v[152:155], v[200:203], v[124:127], v[152:155]
    v_mfma_f32_16x16x32_bf16 v[156:159], v[204:207], v[124:127], v[156:159]
    v_mfma_f32_16x16x32_bf16 v[160:163], v[208:211], v[124:127], v[160:163]
    v_mfma_f32_16x16x32_bf16 v[164:167], v[212:215], v[124:127], v[164:167]
    v_mfma_f32_16x16x32_bf16 v[168:171], v[124:127], v[216:219], v[168:171]
    v_mfma_f32_16x16x32_bf16 v[172:175], v[124:127], v[220:223], v[172:175]
    v_lshlrev_b32 v10, 4, v4
    v_add_u32 v11, 0, v10
    v_add_u32 v12, 4, v10
    v_add_u32 v13, 8, v10
    v_add_u32 v14, 12, v10
    ds_bpermute_b32 v16, v11, v224
    ds_bpermute_b32 v24, v11, v226
    ds_bpermute_b32 v17, v12, v224
    ds_bpermute_b32 v25, v12, v226
    ds_bpermute_b32 v18, v13, v224
    ds_bpermute_b32 v26, v13, v226
    ds_bpermute_b32 v19, v14, v224
    ds_bpermute_b32 v27, v14, v226
    ds_bpermute_b32 v20, v11, v225
    ds_bpermute_b32 v28, v11, v227
    ds_bpermute_b32 v21, v12, v225
    ds_bpermute_b32 v29, v12, v227
    ds_bpermute_b32 v22, v13, v225
    ds_bpermute_b32 v30, v13, v227
    ds_bpermute_b32 v23, v14, v225
    ds_bpermute_b32 v31, v14, v227
    s_lshl_b32 s26, s37, 17
    s_lshl_b32 s27, s12, 10
    s_add_u32 s26, s26, s27
    s_add_u32 s28, s26, 0x900000
    s_add_u32 s27, s26, 0x700000
    s_add_u32 s26, s26, 0x500000
    v_pk_fma_f32 v[136:137], v[224:225], v[236:237], v[136:137] op_sel:[0,0,0] op_sel_hi:[0,1,1]
    v_pk_fma_f32 v[138:139], v[224:225], v[238:239], v[138:139] op_sel:[0,0,0] op_sel_hi:[0,1,1]
    v_pk_mul_f32 v[136:137], v[226:227], v[136:137] op_sel:[0,0] op_sel_hi:[0,1]
    v_pk_mul_f32 v[138:139], v[226:227], v[138:139] op_sel:[0,0] op_sel_hi:[0,1]
    v_pk_fma_f32 v[140:141], v[224:225], v[240:241], v[140:141] op_sel:[0,0,0] op_sel_hi:[0,1,1]
    v_pk_fma_f32 v[142:143], v[224:225], v[242:243], v[142:143] op_sel:[0,0,0] op_sel_hi:[0,1,1]
    v_pk_mul_f32 v[140:141], v[226:227], v[140:141] op_sel:[0,0] op_sel_hi:[0,1]
    v_pk_mul_f32 v[142:143], v[226:227], v[142:143] op_sel:[0,0] op_sel_hi:[0,1]
    v_cvt_pk_bf16_f32 v36, v136, v137
    v_cvt_pk_bf16_f32 v37, v138, v139
    v_cvt_pk_bf16_f32 v38, v140, v141
    v_cvt_pk_bf16_f32 v39, v142, v143
    buffer_store_dwordx4 v[36:39], v5, s[52:55], s27 offen offset:0 sc0 sc1
    v_pk_fma_f32 v[128:129], v[224:225], v[228:229], v[128:129] op_sel:[0,0,0] op_sel_hi:[0,1,1]
    v_pk_fma_f32 v[130:131], v[224:225], v[230:231], v[130:131] op_sel:[0,0,0] op_sel_hi:[0,1,1]
    v_pk_mul_f32 v[128:129], v[226:227], v[128:129] op_sel:[0,0] op_sel_hi:[0,1]
    v_pk_mul_f32 v[130:131], v[226:227], v[130:131] op_sel:[0,0] op_sel_hi:[0,1]
    v_pk_fma_f32 v[132:133], v[224:225], v[232:233], v[132:133] op_sel:[0,0,0] op_sel_hi:[0,1,1]
    v_pk_fma_f32 v[134:135], v[224:225], v[234:235], v[134:135] op_sel:[0,0,0] op_sel_hi:[0,1,1]
    v_pk_mul_f32 v[132:133], v[226:227], v[132:133] op_sel:[0,0] op_sel_hi:[0,1]
    v_pk_mul_f32 v[134:135], v[226:227], v[134:135] op_sel:[0,0] op_sel_hi:[0,1]
    v_cvt_pk_bf16_f32 v32, v128, v129
    v_cvt_pk_bf16_f32 v33, v130, v131
    v_cvt_pk_bf16_f32 v34, v132, v133
    v_cvt_pk_bf16_f32 v35, v134, v135
    buffer_store_dwordx4 v[32:35], v5, s[52:55], s26 offen offset:0 sc0 sc1
    v_pk_fma_f32 v[160:161], v[224:225], v[236:237], v[160:161] op_sel:[1,0,0] op_sel_hi:[1,1,1]
    v_pk_fma_f32 v[162:163], v[224:225], v[238:239], v[162:163] op_sel:[1,0,0] op_sel_hi:[1,1,1]
    v_pk_mul_f32 v[160:161], v[226:227], v[160:161] op_sel:[1,0] op_sel_hi:[1,1]
    v_pk_mul_f32 v[162:163], v[226:227], v[162:163] op_sel:[1,0] op_sel_hi:[1,1]
    v_pk_fma_f32 v[164:165], v[224:225], v[240:241], v[164:165] op_sel:[1,0,0] op_sel_hi:[1,1,1]
    v_pk_fma_f32 v[166:167], v[224:225], v[242:243], v[166:167] op_sel:[1,0,0] op_sel_hi:[1,1,1]
    v_pk_mul_f32 v[164:165], v[226:227], v[164:165] op_sel:[1,0] op_sel_hi:[1,1]
    v_pk_mul_f32 v[166:167], v[226:227], v[166:167] op_sel:[1,0] op_sel_hi:[1,1]
    v_cvt_pk_bf16_f32 v44, v160, v161
    v_cvt_pk_bf16_f32 v45, v162, v163
    v_cvt_pk_bf16_f32 v46, v164, v165
    v_cvt_pk_bf16_f32 v47, v166, v167
    buffer_store_dwordx4 v[44:47], v5, s[52:55], s27 offen offset:1024 sc0 sc1
    v_pk_fma_f32 v[152:153], v[224:225], v[228:229], v[152:153] op_sel:[1,0,0] op_sel_hi:[1,1,1]
    v_pk_fma_f32 v[154:155], v[224:225], v[230:231], v[154:155] op_sel:[1,0,0] op_sel_hi:[1,1,1]
    v_pk_mul_f32 v[152:153], v[226:227], v[152:153] op_sel:[1,0] op_sel_hi:[1,1]
    v_pk_mul_f32 v[154:155], v[226:227], v[154:155] op_sel:[1,0] op_sel_hi:[1,1]
    v_pk_fma_f32 v[156:157], v[224:225], v[232:233], v[156:157] op_sel:[1,0,0] op_sel_hi:[1,1,1]
    v_pk_fma_f32 v[158:159], v[224:225], v[234:235], v[158:159] op_sel:[1,0,0] op_sel_hi:[1,1,1]
    v_pk_mul_f32 v[156:157], v[226:227], v[156:157] op_sel:[1,0] op_sel_hi:[1,1]
    v_pk_mul_f32 v[158:159], v[226:227], v[158:159] op_sel:[1,0] op_sel_hi:[1,1]
    v_cvt_pk_bf16_f32 v40, v152, v153
    v_cvt_pk_bf16_f32 v41, v154, v155
    v_cvt_pk_bf16_f32 v42, v156, v157
    v_cvt_pk_bf16_f32 v43, v158, v159
    buffer_store_dwordx4 v[40:43], v5, s[52:55], s26 offen offset:1024 sc0 sc1
    s_waitcnt lgkmcnt(0)
    v_cmp_eq_u32 vcc, 12, v3
    v_fma_f32 v144, v16, v252, v144
    v_fma_f32 v145, v17, v252, v145
    v_fma_f32 v146, v18, v252, v146
    v_fma_f32 v147, v19, v252, v147
    v_pk_mul_f32 v[144:145], v[24:25], v[144:145]
    v_pk_mul_f32 v[146:147], v[26:27], v[146:147]
    v_fma_f32 v168, v20, v252, v168
    v_fma_f32 v169, v21, v252, v169
    v_fma_f32 v170, v22, v252, v170
    v_fma_f32 v171, v23, v252, v171
    v_pk_mul_f32 v[168:169], v[28:29], v[168:169]
    v_pk_mul_f32 v[170:171], v[30:31], v[170:171]
    v_cvt_pk_bf16_f32 v48, v144, v145
    v_cvt_pk_bf16_f32 v49, v146, v147
    v_cvt_pk_bf16_f32 v50, v168, v169
    v_cvt_pk_bf16_f32 v51, v170, v171
    buffer_store_dwordx4 v[48:51], v5, s[52:55], s28 offen offset:0 sc0 sc1
    v_fma_f32 v148, v16, v253, v148
    v_fma_f32 v149, v17, v253, v149
    v_fma_f32 v150, v18, v253, v150
    v_fma_f32 v151, v19, v253, v151
    v_pk_mul_f32 v[148:149], v[24:25], v[148:149]
    v_pk_mul_f32 v[150:151], v[26:27], v[150:151]
    v_cndmask_b32 v148, v148, 1.0, vcc
    v_cndmask_b32 v149, v149, 1.0, vcc
    v_cndmask_b32 v150, v150, 1.0, vcc
    v_cndmask_b32 v151, v151, 1.0, vcc
    v_fma_f32 v172, v20, v253, v172
    v_fma_f32 v173, v21, v253, v173
    v_fma_f32 v174, v22, v253, v174
    v_fma_f32 v175, v23, v253, v175
    v_pk_mul_f32 v[172:173], v[28:29], v[172:173]
    v_pk_mul_f32 v[174:175], v[30:31], v[174:175]
    v_cndmask_b32 v172, v172, 1.0, vcc
    v_cndmask_b32 v173, v173, 1.0, vcc
    v_cndmask_b32 v174, v174, 1.0, vcc
    v_cndmask_b32 v175, v175, 1.0, vcc
    v_cvt_pk_bf16_f32 v52, v148, v149
    v_cvt_pk_bf16_f32 v53, v150, v151
    v_cvt_pk_bf16_f32 v54, v172, v173
    v_cvt_pk_bf16_f32 v55, v174, v175
    buffer_store_dwordx4 v[52:55], v5, s[52:55], s28 offen offset:1024 sc0 sc1
    s_sub_u32 s41, s36, 0
    s_lshl_b32 s41, s41, 4
    s_add_u32 s41, s41, s37
    s_lshl_b32 s41, s41, 7
    s_add_u32 s41, s41, 0x448000
    s_waitcnt vmcnt(0)
    s_barrier
    s_cmp_lg_u32 s3, 0
    s_cbranch_scc1 L_sig_11
    s_mov_b64 exec, 1
    v_mov_b32 v254, 1
    v_mov_b32 v255, 0
    buffer_atomic_add v254, v255, s[52:55], s41 offen sc1
    s_mov_b64 exec, -1
L_sig_11:
    s_cmp_eq_u32 s36, 0
    s_cbranch_scc1 L_kv_done
    s_cmp_lg_u32 s3, 0
    s_cbranch_scc1 L_kv_done
    s_cmp_ge_u32 s36, 2
    s_cselect_b32 s45, 2048, 0
    s_cselect_b32 s46, 2, 1
    s_sub_u32 s41, s36, s46
    s_lshl_b32 s41, s41, 4
    s_add_u32 s41, s41, s37
    s_lshl_b32 s41, s41, 7
    s_add_u32 s41, s41, 0x448000
    v_and_b32 v255, 1, v0
    v_mul_u32_u24 v255, s45, v255
    s_mov_b32 s42, 0x40000
L_kv_loop:
    buffer_load_dword v254, v255, s[52:55], s41 offen sc0 sc1
    s_waitcnt vmcnt(0)
    v_readlane_b32 s43, v254, 0
    v_readlane_b32 s46, v254, 1
    s_min_u32 s43, s43, s46
    s_cmp_ge_u32 s43, 1
    s_cbranch_scc1 L_kv_done
    s_sub_u32 s42, s42, 1
    s_cmp_eq_u32 s42, 0
    s_cbranch_scc1 L_kv_done
    s_sleep 1
    s_branch L_kv_loop
L_kv_done:
    s_barrier
    s_lshl_b32 s11, s36, 2
    s_add_u32 s11, s11, s3
    s_lshl_b32 s12, s37, 17
    s_lshl_b32 s13, s11, 11
    s_add_u32 s13, s12, s13
    s_add_u32 s14, s13, 0x500000
    s_add_u32 s15, s13, 0x6fc000
    s_add_u32 s16, s12, 0x900000
    s_sub_i32 s18, s11, 8
    buffer_load_dwordx4 v[8:11], v5, s[52:55], s14 offen offset:0
    buffer_load_dwordx4 v[12:15], v5, s[52:55], s14 offen offset:1024
    s_lshl_b32 s10, s11, 1
    s_sub_i32 s10, s10, 16
    s_add_u32 s15, s12, 0x700000
    s_add_i32 s19, s10, 0
    s_max_i32 s19, s19, 0
    s_lshl_b32 s19, s19, 10
    s_add_u32 s19, s19, s15
    buffer_load_dwordx4 a[0:3], v5, s[52:55], s19 offen
    s_add_i32 s19, s10, 1
    s_max_i32 s19, s19, 0
    s_lshl_b32 s19, s19, 10
    s_add_u32 s19, s19, s15
    buffer_load_dwordx4 a[4:7], v5, s[52:55], s19 offen
    s_add_i32 s19, s10, 2
    s_max_i32 s19, s19, 0
    s_lshl_b32 s19, s19, 10
    s_add_u32 s19, s19, s15
    buffer_load_dwordx4 a[8:11], v5, s[52:55], s19 offen
    s_add_i32 s19, s10, 3
    s_max_i32 s19, s19, 0
    s_lshl_b32 s19, s19, 10
    s_add_u32 s19, s19, s15
    buffer_load_dwordx4 a[12:15], v5, s[52:55], s19 offen
    s_add_i32 s19, s10, 4
    s_max_i32 s19, s19, 0
    s_lshl_b32 s19, s19, 10
    s_add_u32 s19, s19, s15
    buffer_load_dwordx4 a[16:19], v5, s[52:55], s19 offen
    s_add_i32 s19, s10, 5
    s_max_i32 s19, s19, 0
    s_lshl_b32 s19, s19, 10
    s_add_u32 s19, s19, s15
    buffer_load_dwordx4 a[20:23], v5, s[52:55], s19 offen
    s_add_i32 s19, s10, 6
    s_max_i32 s19, s19, 0
    s_lshl_b32 s19, s19, 10
    s_add_u32 s19, s19, s15
    buffer_load_dwordx4 a[24:27], v5, s[52:55], s19 offen
    s_add_i32 s19, s10, 7
    s_max_i32 s19, s19, 0
    s_lshl_b32 s19, s19, 10
    s_add_u32 s19, s19, s15
    buffer_load_dwordx4 a[28:31], v5, s[52:55], s19 offen
    s_add_i32 s19, s10, 8
    s_max_i32 s19, s19, 0
    s_lshl_b32 s19, s19, 10
    s_add_u32 s19, s19, s15
    buffer_load_dwordx4 a[32:35], v5, s[52:55], s19 offen
    s_add_i32 s19, s10, 9
    s_max_i32 s19, s19, 0
    s_lshl_b32 s19, s19, 10
    s_add_u32 s19, s19, s15
    buffer_load_dwordx4 a[36:39], v5, s[52:55], s19 offen
    s_add_i32 s19, s10, 10
    s_max_i32 s19, s19, 0
    s_lshl_b32 s19, s19, 10
    s_add_u32 s19, s19, s15
    buffer_load_dwordx4 a[40:43], v5, s[52:55], s19 offen
    s_add_i32 s19, s10, 11
    s_max_i32 s19, s19, 0
    s_lshl_b32 s19, s19, 10
    s_add_u32 s19, s19, s15
    buffer_load_dwordx4 a[44:47], v5, s[52:55], s19 offen
    s_add_i32 s19, s10, 12
    s_max_i32 s19, s19, 0
    s_lshl_b32 s19, s19, 10
    s_add_u32 s19, s19, s15
    buffer_load_dwordx4 a[48:51], v5, s[52:55], s19 offen
    s_add_i32 s19, s10, 13
    s_max_i32 s19, s19, 0
    s_lshl_b32 s19, s19, 10
    s_add_u32 s19, s19, s15
    buffer_load_dwordx4 a[52:55], v5, s[52:55], s19 offen
    s_add_i32 s19, s10, 14
    s_max_i32 s19, s19, 0
    s_lshl_b32 s19, s19, 10
    s_add_u32 s19, s19, s15
    buffer_load_dwordx4 a[56:59], v5, s[52:55], s19 offen
    s_add_i32 s19, s10, 15
    s_max_i32 s19, s19, 0
    s_lshl_b32 s19, s19, 10
    s_add_u32 s19, s19, s15
    buffer_load_dwordx4 a[60:63], v5, s[52:55], s19 offen
    s_add_i32 s19, s10, 16
    s_max_i32 s19, s19, 0
    s_lshl_b32 s19, s19, 10
    s_add_u32 s19, s19, s15
    buffer_load_dwordx4 a[64:67], v5, s[52:55], s19 offen
    s_add_i32 s19, s10, 17
    s_max_i32 s19, s19, 0
    s_lshl_b32 s19, s19, 10
    s_add_u32 s19, s19, s15
    buffer_load_dwordx4 a[68:71], v5, s[52:55], s19 offen
    v_lshlrev_b32 v6, 2, v4
    v_add_u32 v7, 0, v6
    v_cmp_ge_u32 s[20:21], v3, v7
    v_add_u32 v7, 1, v6
    v_cmp_ge_u32 s[22:23], v3, v7
    v_add_u32 v7, 2, v6
    v_cmp_ge_u32 s[24:25], v3, v7
    v_add_u32 v7, 3, v6
    v_cmp_ge_u32 s[26:27], v3, v7
    v_mov_b32 v6, 0xff800000
    s_add_i32 s19, s18, 0
    s_max_i32 s19, s19, 0
    s_lshl_b32 s19, s19, 11
    s_add_u32 s19, s19, s16
    buffer_load_dwordx4 a[72:75], v5, s[52:55], s19 offen offset:0
    s_waitcnt vmcnt(18)
    v_mfma_f32_16x16x32_bf16 v[16:19], a[0:3], v[8:11], 0
    buffer_load_dwordx4 a[76:79], v5, s[52:55], s19 offen offset:1024
    s_waitcnt vmcnt(18)
    v_mfma_f32_16x16x32_bf16 v[20:23], a[4:7], v[8:11], 0
    v_mfma_f32_16x16x32_bf16 v[92:95], a[4:7], v[12:15], 0
    s_add_i32 s19, s18, 1
    s_max_i32 s19, s19, 0
    s_lshl_b32 s19, s19, 11
    s_add_u32 s19, s19, s16
    buffer_load_dwordx4 a[80:83], v5, s[52:55], s19 offen offset:0
    s_waitcnt vmcnt(18)
    v_mfma_f32_16x16x32_bf16 v[24:27], a[8:11], v[8:11], 0
    v_mfma_f32_16x16x32_bf16 v[96:99], a[8:11], v[12:15], 0
    buffer_load_dwordx4 a[84:87], v5, s[52:55], s19 offen offset:1024
    s_waitcnt vmcnt(18)
    v_mfma_f32_16x16x32_bf16 v[28:31], a[12:15], v[8:11], 0
    v_mfma_f32_16x16x32_bf16 v[100:103], a[12:15], v[12:15], 0
    s_add_i32 s19, s18, 2
    s_max_i32 s19, s19, 0
    s_lshl_b32 s19, s19, 11
    s_add_u32 s19, s19, s16
    buffer_load_dwordx4 a[88:91], v5, s[52:55], s19 offen offset:0
    s_waitcnt vmcnt(18)
    v_mfma_f32_16x16x32_bf16 v[32:35], a[16:19], v[8:11], 0
    v_mfma_f32_16x16x32_bf16 v[104:107], a[16:19], v[12:15], 0
    buffer_load_dwordx4 a[92:95], v5, s[52:55], s19 offen offset:1024
    s_waitcnt vmcnt(18)
    v_mfma_f32_16x16x32_bf16 v[36:39], a[20:23], v[8:11], 0
    v_mfma_f32_16x16x32_bf16 v[108:111], a[20:23], v[12:15], 0
    s_add_i32 s19, s18, 3
    s_max_i32 s19, s19, 0
    s_lshl_b32 s19, s19, 11
    s_add_u32 s19, s19, s16
    buffer_load_dwordx4 a[96:99], v5, s[52:55], s19 offen offset:0
    s_waitcnt vmcnt(18)
    v_mfma_f32_16x16x32_bf16 v[40:43], a[24:27], v[8:11], 0
    v_mfma_f32_16x16x32_bf16 v[112:115], a[24:27], v[12:15], 0
    buffer_load_dwordx4 a[100:103], v5, s[52:55], s19 offen offset:1024
    s_waitcnt vmcnt(18)
    v_mfma_f32_16x16x32_bf16 v[44:47], a[28:31], v[8:11], 0
    v_mfma_f32_16x16x32_bf16 v[116:119], a[28:31], v[12:15], 0
    s_add_i32 s19, s18, 4
    s_max_i32 s19, s19, 0
    s_lshl_b32 s19, s19, 11
    s_add_u32 s19, s19, s16
    buffer_load_dwordx4 a[104:107], v5, s[52:55], s19 offen offset:0
    s_waitcnt vmcnt(18)
    v_mfma_f32_16x16x32_bf16 v[48:51], a[32:35], v[8:11], 0
    v_mfma_f32_16x16x32_bf16 v[120:123], a[32:35], v[12:15], 0
    buffer_load_dwordx4 a[108:111], v5, s[52:55], s19 offen offset:1024
    s_waitcnt vmcnt(18)
    v_mfma_f32_16x16x32_bf16 v[52:55], a[36:39], v[8:11], 0
    s_add_i32 s19, s18, 5
    s_max_i32 s19, s19, 0
    s_lshl_b32 s19, s19, 11
    s_add_u32 s19, s19, s16
    buffer_load_dwordx4 a[112:115], v5, s[52:55], s19 offen offset:0
    v_mfma_f32_16x16x32_bf16 v[124:127], a[36:39], v[12:15], 0
    s_waitcnt vmcnt(18)
    v_mfma_f32_16x16x32_bf16 v[56:59], a[40:43], v[8:11], 0
    buffer_load_dwordx4 a[116:119], v5, s[52:55], s19 offen offset:1024
    v_mfma_f32_16x16x32_bf16 v[128:131], a[40:43], v[12:15], 0
    s_waitcnt vmcnt(18)
    v_mfma_f32_16x16x32_bf16 v[60:63], a[44:47], v[8:11], 0
    s_add_i32 s19, s18, 6
    s_max_i32 s19, s19, 0
    s_lshl_b32 s19, s19, 11
    s_add_u32 s19, s19, s16
    buffer_load_dwordx4 a[120:123], v5, s[52:55], s19 offen offset:0
    v_mfma_f32_16x16x32_bf16 v[132:135], a[44:47], v[12:15], 0
    s_waitcnt vmcnt(18)
    v_mfma_f32_16x16x32_bf16 v[64:67], a[48:51], v[8:11], 0
    buffer_load_dwordx4 a[124:127], v5, s[52:55], s19 offen offset:1024
    v_mfma_f32_16x16x32_bf16 v[136:139], a[48:51], v[12:15], 0
    s_waitcnt vmcnt(18)
    v_mfma_f32_16x16x32_bf16 v[68:71], a[52:55], v[8:11], 0
    s_add_i32 s19, s18, 7
    s_max_i32 s19, s19, 0
    s_lshl_b32 s19, s19, 11
    s_add_u32 s19, s19, s16
    buffer_load_dwordx4 a[128:131], v5, s[52:55], s19 offen offset:0
    v_mfma_f32_16x16x32_bf16 v[140:143], a[52:55], v[12:15], 0
    s_waitcnt vmcnt(18)
    v_mfma_f32_16x16x32_bf16 v[72:75], a[56:59], v[8:11], 0
    buffer_load_dwordx4 a[132:135], v5, s[52:55], s19 offen offset:1024
    v_mfma_f32_16x16x32_bf16 v[144:147], a[56:59], v[12:15], 0
    s_waitcnt vmcnt(18)
    v_mfma_f32_16x16x32_bf16 v[76:79], a[60:63], v[8:11], 0
    s_add_i32 s19, s18, 8
    s_max_i32 s19, s19, 0
    s_lshl_b32 s19, s19, 11
    s_add_u32 s19, s19, s16
    buffer_load_dwordx4 a[136:139], v5, s[52:55], s19 offen offset:0
    v_mfma_f32_16x16x32_bf16 v[148:151], a[60:63], v[12:15], 0
    s_waitcnt vmcnt(18)
    v_mfma_f32_16x16x32_bf16 v[80:83], a[64:67], v[8:11], 0
    buffer_load_dwordx4 a[140:143], v5, s[52:55], s19 offen offset:1024
    v_mfma_f32_16x16x32_bf16 v[152:155], a[64:67], v[12:15], 0
    s_waitcnt vmcnt(18)
    v_mfma_f32_16x16x32_bf16 v[156:159], a[68:71], v[12:15], 0
    s_nop 7
    s_lshl_b32 s17, s11, 1
    s_sub_i32 s17, 16, s17
    s_cmp_le_i32 s17, 0
    s_cbranch_scc1 L_attn_noneg_0
    s_cmp_le_i32 s17, 0
    s_cbranch_scc1 L_attn_neg_12
    v_mov_b32 v16, v6
    v_mov_b32 v17, v6
    v_mov_b32 v18, v6
    v_mov_b32 v19, v6
L_attn_neg_12:
    s_cmp_le_i32 s17, 1
    s_cbranch_scc1 L_attn_neg_13
    v_mov_b32 v20, v6
    v_mov_b32 v21, v6
    v_mov_b32 v22, v6
    v_mov_b32 v23, v6
    v_mov_b32 v92, v6
    v_mov_b32 v93, v6
    v_mov_b32 v94, v6
    v_mov_b32 v95, v6
L_attn_neg_13:
    s_cmp_le_i32 s17, 2
    s_cbranch_scc1 L_attn_neg_14
    v_mov_b32 v24, v6
    v_mov_b32 v25, v6
    v_mov_b32 v26, v6
    v_mov_b32 v27, v6
    v_mov_b32 v96, v6
    v_mov_b32 v97, v6
    v_mov_b32 v98, v6
    v_mov_b32 v99, v6
L_attn_neg_14:
    s_cmp_le_i32 s17, 3
    s_cbranch_scc1 L_attn_neg_15
    v_mov_b32 v28, v6
    v_mov_b32 v29, v6
    v_mov_b32 v30, v6
    v_mov_b32 v31, v6
    v_mov_b32 v100, v6
    v_mov_b32 v101, v6
    v_mov_b32 v102, v6
    v_mov_b32 v103, v6
L_attn_neg_15:
    s_cmp_le_i32 s17, 4
    s_cbranch_scc1 L_attn_neg_16
    v_mov_b32 v32, v6
    v_mov_b32 v33, v6
    v_mov_b32 v34, v6
    v_mov_b32 v35, v6
    v_mov_b32 v104, v6
    v_mov_b32 v105, v6
    v_mov_b32 v106, v6
    v_mov_b32 v107, v6
L_attn_neg_16:
    s_cmp_le_i32 s17, 5
    s_cbranch_scc1 L_attn_neg_17
    v_mov_b32 v36, v6
    v_mov_b32 v37, v6
    v_mov_b32 v38, v6
    v_mov_b32 v39, v6
    v_mov_b32 v108, v6
    v_mov_b32 v109, v6
    v_mov_b32 v110, v6
    v_mov_b32 v111, v6
L_attn_neg_17:
    s_cmp_le_i32 s17, 6
    s_cbranch_scc1 L_attn_neg_18
    v_mov_b32 v40, v6
    v_mov_b32 v41, v6
    v_mov_b32 v42, v6
    v_mov_b32 v43, v6
    v_mov_b32 v112, v6
    v_mov_b32 v113, v6
    v_mov_b32 v114, v6
    v_mov_b32 v115, v6
L_attn_neg_18:
    s_cmp_le_i32 s17, 7
    s_cbranch_scc1 L_attn_neg_19
    v_mov_b32 v44, v6
    v_mov_b32 v45, v6
    v_mov_b32 v46, v6
    v_mov_b32 v47, v6
    v_mov_b32 v116, v6
    v_mov_b32 v117, v6
    v_mov_b32 v118, v6
    v_mov_b32 v119, v6
L_attn_neg_19:
    s_cmp_le_i32 s17, 8
    s_cbranch_scc1 L_attn_neg_20
    v_mov_b32 v48, v6
    v_mov_b32 v49, v6
    v_mov_b32 v50, v6
    v_mov_b32 v51, v6
    v_mov_b32 v120, v6
    v_mov_b32 v121, v6
    v_mov_b32 v122, v6
    v_mov_b32 v123, v6
L_attn_neg_20:
    s_cmp_le_i32 s17, 9
    s_cbranch_scc1 L_attn_neg_21
    v_mov_b32 v52, v6
    v_mov_b32 v53, v6
    v_mov_b32 v54, v6
    v_mov_b32 v55, v6
    v_mov_b32 v124, v6
    v_mov_b32 v125, v6
    v_mov_b32 v126, v6
    v_mov_b32 v127, v6
L_attn_neg_21:
    s_cmp_le_i32 s17, 10
    s_cbranch_scc1 L_attn_neg_22
    v_mov_b32 v56, v6
    v_mov_b32 v57, v6
    v_mov_b32 v58, v6
    v_mov_b32 v59, v6
    v_mov_b32 v128, v6
    v_mov_b32 v129, v6
    v_mov_b32 v130, v6
    v_mov_b32 v131, v6
L_attn_neg_22:
    s_cmp_le_i32 s17, 11
    s_cbranch_scc1 L_attn_neg_23
    v_mov_b32 v60, v6
    v_mov_b32 v61, v6
    v_mov_b32 v62, v6
    v_mov_b32 v63, v6
    v_mov_b32 v132, v6
    v_mov_b32 v133, v6
    v_mov_b32 v134, v6
    v_mov_b32 v135, v6
L_attn_neg_23:
    s_cmp_le_i32 s17, 12
    s_cbranch_scc1 L_attn_neg_24
    v_mov_b32 v64, v6
    v_mov_b32 v65, v6
    v_mov_b32 v66, v6
    v_mov_b32 v67, v6
    v_mov_b32 v136, v6
    v_mov_b32 v137, v6
    v_mov_b32 v138, v6
    v_mov_b32 v139, v6
L_attn_neg_24:
    s_cmp_le_i32 s17, 13
    s_cbranch_scc1 L_attn_neg_25
    v_mov_b32 v68, v6
    v_mov_b32 v69, v6
    v_mov_b32 v70, v6
    v_mov_b32 v71, v6
    v_mov_b32 v140, v6
    v_mov_b32 v141, v6
    v_mov_b32 v142, v6
    v_mov_b32 v143, v6
L_attn_neg_25:
    s_cmp_le_i32 s17, 14
    s_cbranch_scc1 L_attn_neg_26
    v_mov_b32 v72, v6
    v_mov_b32 v73, v6
    v_mov_b32 v74, v6
    v_mov_b32 v75, v6
    v_mov_b32 v144, v6
    v_mov_b32 v145, v6
    v_mov_b32 v146, v6
    v_mov_b32 v147, v6
L_attn_neg_26:
    s_cmp_le_i32 s17, 15
    s_cbranch_scc1 L_attn_neg_27
    v_mov_b32 v76, v6
    v_mov_b32 v77, v6
    v_mov_b32 v78, v6
    v_mov_b32 v79, v6
    v_mov_b32 v148, v6
    v_mov_b32 v149, v6
    v_mov_b32 v150, v6
    v_mov_b32 v151, v6
L_attn_neg_27:
L_attn_noneg_0:
    v_cndmask_b32 v16, v16, v6, s[20:21]
    v_cndmask_b32 v80, v6, v80, s[20:21]
    v_cndmask_b32 v17, v17, v6, s[22:23]
    v_cndmask_b32 v81, v6, v81, s[22:23]
    v_cndmask_b32 v18, v18, v6, s[24:25]
    v_cndmask_b32 v82, v6, v82, s[24:25]
    v_cndmask_b32 v19, v19, v6, s[26:27]
    v_cndmask_b32 v83, v6, v83, s[26:27]
    v_cndmask_b32 v92, v92, v6, s[20:21]
    v_cndmask_b32 v156, v6, v156, s[20:21]
    v_cndmask_b32 v93, v93, v6, s[22:23]
    v_cndmask_b32 v157, v6, v157, s[22:23]
    v_cndmask_b32 v94, v94, v6, s[24:25]
    v_cndmask_b32 v158, v6, v158, s[24:25]
    v_cndmask_b32 v95, v95, v6, s[26:27]
    v_cndmask_b32 v159, v6, v159, s[26:27]
    v_max_f32 v176, v16, v17
    v_max_f32 v177, v92, v93
    v_max3_f32 v176, v176, v18, v19
    v_max3_f32 v177, v177, v94, v95
    v_max3_f32 v176, v176, v20, v21
    v_max3_f32 v177, v177, v96, v97
    v_max3_f32 v176, v176, v22, v23
    v_max3_f32 v177, v177, v98, v99
    v_max3_f32 v176, v176, v24, v25
    v_max3_f32 v177, v177, v100, v101
    v_max3_f32 v176, v176, v26, v27
    v_max3_f32 v177, v177, v102, v103
    v_max3_f32 v176, v176, v28, v29
    v_max3_f32 v177, v177, v104, v105
    v_max3_f32 v176, v176, v30, v31
    v_max3_f32 v177, v177, v106, v107
    v_max3_f32 v176, v176, v32, v33
    v_max3_f32 v177, v177, v108, v109
    v_max3_f32 v176, v176, v34, v35
    v_max3_f32 v177, v177, v110, v111
    v_max3_f32 v176, v176, v36, v37
    v_max3_f32 v177, v177, v112, v113
    v_max3_f32 v176, v176, v38, v39
    v_max3_f32 v177, v177, v114, v115
    v_max3_f32 v176, v176, v40, v41
    v_max3_f32 v177, v177, v116, v117
    v_max3_f32 v176, v176, v42, v43
    v_max3_f32 v177, v177, v118, v119
    v_max3_f32 v176, v176, v44, v45
    v_max3_f32 v177, v177, v120, v121
    v_max3_f32 v176, v176, v46, v47
    v_max3_f32 v177, v177, v122, v123
    v_max3_f32 v176, v176, v48, v49
    v_max3_f32 v177, v177, v124, v125
    v_max3_f32 v176, v176, v50, v51
    v_max3_f32 v177, v177, v126, v127
    v_max3_f32 v176, v176, v52, v53
    v_max3_f32 v177, v177, v128, v129
    v_max3_f32 v176, v176, v54, v55
    v_max3_f32 v177, v177, v130, v131
    v_max3_f32 v176, v176, v56, v57
    v_max3_f32 v177, v177, v132, v133
    v_max3_f32 v176, v176, v58, v59
    v_max3_f32 v177, v177, v134, v135
    v_max3_f32 v176, v176, v60, v61
    v_max3_f32 v177, v177, v136, v137
    v_max3_f32 v176, v176, v62, v63
    v_max3_f32 v177, v177, v138, v139
    v_max3_f32 v176, v176, v64, v65
    v_max3_f32 v177, v177, v140, v141
    v_max3_f32 v176, v176, v66, v67
    v_max3_f32 v177, v177, v142, v143
    v_max3_f32 v176, v176, v68, v69
    v_max3_f32 v177, v177, v144, v145
    v_max3_f32 v176, v176, v70, v71
    v_max3_f32 v177, v177, v146, v147
    v_max3_f32 v176, v176, v72, v73
    v_max3_f32 v177, v177, v148, v149
    v_max3_f32 v176, v176, v74, v75
    v_max3_f32 v177, v177, v150, v151
    v_max3_f32 v176, v176, v76, v77
    v_max3_f32 v177, v177, v152, v153
    v_max3_f32 v176, v176, v78, v79
    v_max3_f32 v177, v177, v154, v155
    v_max3_f32 v176, v176, v80, v81
    v_max3_f32 v177, v177, v156, v157
    v_max3_f32 v176, v176, v82, v83
    v_max3_f32 v177, v177, v158, v159
    v_mov_b32 v178, v176
    v_mov_b32 v179, v177
    s_nop 1
    v_permlane16_swap_b32 v176, v178
    v_permlane16_swap_b32 v177, v179
    v_max_f32 v176, v176, v178
    v_max_f32 v177, v177, v179
    v_mov_b32 v178, v176
    v_mov_b32 v179, v177
    s_nop 1
    v_permlane32_swap_b32 v176, v178
    v_permlane32_swap_b32 v177, v179
    v_max_f32 v176, v176, v178
    v_max_f32 v177, v177, v179
    s_mov_b32 s28, 0x3e8b97f6
    v_mov_b32 v188, s28
    v_mov_b32 v189, s28
    v_mul_f32 v180, -v188, v176
    v_mul_f32 v181, -v188, v176
    v_mul_f32 v182, -v188, v177
    v_mul_f32 v183, -v188, v177
    v_pk_fma_f32 v[16:17], v[16:17], v[188:189], v[180:181]
    v_pk_fma_f32 v[18:19], v[18:19], v[188:189], v[180:181]
    v_exp_f32 v16, v16
    v_exp_f32 v17, v17
    v_exp_f32 v18, v18
    v_exp_f32 v19, v19
    v_pk_fma_f32 v[20:21], v[20:21], v[188:189], v[180:181]
    v_pk_fma_f32 v[22:23], v[22:23], v[188:189], v[180:181]
    v_exp_f32 v20, v20
    v_exp_f32 v21, v21
    v_exp_f32 v22, v22
    v_exp_f32 v23, v23
    v_pk_fma_f32 v[24:25], v[24:25], v[188:189], v[180:181]
    v_pk_fma_f32 v[26:27], v[26:27], v[188:189], v[180:181]
    v_exp_f32 v24, v24
    v_exp_f32 v25, v25
    v_exp_f32 v26, v26
    v_exp_f32 v27, v27
    v_pk_fma_f32 v[28:29], v[28:29], v[188:189], v[180:181]
    v_pk_fma_f32 v[30:31], v[30:31], v[188:189], v[180:181]
    v_exp_f32 v28, v28
    v_exp_f32 v29, v29
    v_exp_f32 v30, v30
    v_exp_f32 v31, v31
    v_pk_fma_f32 v[32:33], v[32:33], v[188:189], v[180:181]
    v_pk_fma_f32 v[34:35], v[34:35], v[188:189], v[180:181]
    v_exp_f32 v32, v32
    v_exp_f32 v33, v33
    v_exp_f32 v34, v34
    v_exp_f32 v35, v35
    v_pk_fma_f32 v[36:37], v[36:37], v[188:189], v[180:181]
    v_pk_fma_f32 v[38:39], v[38:39], v[188:189], v[180:181]
    v_exp_f32 v36, v36
    v_exp_f32 v37, v37
    v_exp_f32 v38, v38
    v_exp_f32 v39, v39
    v_pk_fma_f32 v[40:41], v[40:41], v[188:189], v[180:181]
    v_pk_fma_f32 v[42:43], v[42:43], v[188:189], v[180:181]
    v_exp_f32 v40, v40
    v_exp_f32 v41, v41
    v_exp_f32 v42, v42
    v_exp_f32 v43, v43
    v_pk_fma_f32 v[44:45], v[44:45], v[188:189], v[180:181]
    v_pk_fma_f32 v[46:47], v[46:47], v[188:189], v[180:181]
    v_exp_f32 v44, v44
    v_exp_f32 v45, v45
    v_exp_f32 v46, v46
    v_exp_f32 v47, v47
    v_pk_fma_f32 v[48:49], v[48:49], v[188:189], v[180:181]
    v_pk_fma_f32 v[50:51], v[50:51], v[188:189], v[180:181]
    v_exp_f32 v48, v48
    v_exp_f32 v49, v49
    v_exp_f32 v50, v50
    v_exp_f32 v51, v51
    v_pk_fma_f32 v[52:53], v[52:53], v[188:189], v[180:181]
    v_pk_fma_f32 v[54:55], v[54:55], v[188:189], v[180:181]
    v_exp_f32 v52, v52
    v_exp_f32 v53, v53
    v_exp_f32 v54, v54
    v_exp_f32 v55, v55
    v_pk_fma_f32 v[56:57], v[56:57], v[188:189], v[180:181]
    v_pk_fma_f32 v[58:59], v[58:59], v[188:189], v[180:181]
    v_exp_f32 v56, v56
    v_exp_f32 v57, v57
    v_exp_f32 v58, v58
    v_exp_f32 v59, v59
    v_pk_fma_f32 v[60:61], v[60:61], v[188:189], v[180:181]
    v_pk_fma_f32 v[62:63], v[62:63], v[188:189], v[180:181]
    v_exp_f32 v60, v60
    v_exp_f32 v61, v61
    v_exp_f32 v62, v62
    v_exp_f32 v63, v63
    v_pk_fma_f32 v[64:65], v[64:65], v[188:189], v[180:181]
    v_pk_fma_f32 v[66:67], v[66:67], v[188:189], v[180:181]
    v_exp_f32 v64, v64
    v_exp_f32 v65, v65
    v_exp_f32 v66, v66
    v_exp_f32 v67, v67
    v_pk_fma_f32 v[68:69], v[68:69], v[188:189], v[180:181]
    v_pk_fma_f32 v[70:71], v[70:71], v[188:189], v[180:181]
    v_exp_f32 v68, v68
    v_exp_f32 v69, v69
    v_exp_f32 v70, v70
    v_exp_f32 v71, v71
    v_pk_fma_f32 v[72:73], v[72:73], v[188:189], v[180:181]
    v_pk_fma_f32 v[74:75], v[74:75], v[188:189], v[180:181]
    v_exp_f32 v72, v72
    v_exp_f32 v73, v73
    v_exp_f32 v74, v74
    v_exp_f32 v75, v75
    v_pk_fma_f32 v[76:77], v[76:77], v[188:189], v[180:181]
    v_pk_fma_f32 v[78:79], v[78:79], v[188:189], v[180:181]
    v_exp_f32 v76, v76
    v_exp_f32 v77, v77
    v_exp_f32 v78, v78
    v_exp_f32 v79, v79
    v_pk_fma_f32 v[80:81], v[80:81], v[188:189], v[180:181]
    v_pk_fma_f32 v[82:83], v[82:83], v[188:189], v[180:181]
    v_exp_f32 v80, v80
    v_exp_f32 v81, v81
    v_exp_f32 v82, v82
    v_exp_f32 v83, v83
    v_pk_fma_f32 v[92:93], v[92:93], v[188:189], v[182:183]
    v_pk_fma_f32 v[94:95], v[94:95], v[188:189], v[182:183]
    v_exp_f32 v92, v92
    v_exp_f32 v93, v93
    v_exp_f32 v94, v94
    v_exp_f32 v95, v95
    v_pk_fma_f32 v[96:97], v[96:97], v[188:189], v[182:183]
    v_pk_fma_f32 v[98:99], v[98:99], v[188:189], v[182:183]
    v_exp_f32 v96, v96
    v_exp_f32 v97, v97
    v_exp_f32 v98, v98
    v_exp_f32 v99, v99
    v_pk_fma_f32 v[100:101], v[100:101], v[188:189], v[182:183]
    v_pk_fma_f32 v[102:103], v[102:103], v[188:189], v[182:183]
    v_exp_f32 v100, v100
    v_exp_f32 v101, v101
    v_exp_f32 v102, v102
    v_exp_f32 v103, v103
    v_pk_fma_f32 v[104:105], v[104:105], v[188:189], v[182:183]
    v_pk_fma_f32 v[106:107], v[106:107], v[188:189], v[182:183]
    v_exp_f32 v104, v104
    v_exp_f32 v105, v105
    v_exp_f32 v106, v106
    v_exp_f32 v107, v107
    v_pk_fma_f32 v[108:109], v[108:109], v[188:189], v[182:183]
    v_pk_fma_f32 v[110:111], v[110:111], v[188:189], v[182:183]
    v_exp_f32 v108, v108
    v_exp_f32 v109, v109
    v_exp_f32 v110, v110
    v_exp_f32 v111, v111
    v_pk_fma_f32 v[112:113], v[112:113], v[188:189], v[182:183]
    v_pk_fma_f32 v[114:115], v[114:115], v[188:189], v[182:183]
    v_exp_f32 v112, v112
    v_exp_f32 v113, v113
    v_exp_f32 v114, v114
    v_exp_f32 v115, v115
    v_pk_fma_f32 v[116:117], v[116:117], v[188:189], v[182:183]
    v_pk_fma_f32 v[118:119], v[118:119], v[188:189], v[182:183]
    v_exp_f32 v116, v116
    v_exp_f32 v117, v117
    v_exp_f32 v118, v118
    v_exp_f32 v119, v119
    v_pk_fma_f32 v[120:121], v[120:121], v[188:189], v[182:183]
    v_pk_fma_f32 v[122:123], v[122:123], v[188:189], v[182:183]
    v_exp_f32 v120, v120
    v_exp_f32 v121, v121
    v_exp_f32 v122, v122
    v_exp_f32 v123, v123
    v_pk_fma_f32 v[124:125], v[124:125], v[188:189], v[182:183]
    v_pk_fma_f32 v[126:127], v[126:127], v[188:189], v[182:183]
    v_exp_f32 v124, v124
    v_exp_f32 v125, v125
    v_exp_f32 v126, v126
    v_exp_f32 v127, v127
    v_pk_fma_f32 v[128:129], v[128:129], v[188:189], v[182:183]
    v_pk_fma_f32 v[130:131], v[130:131], v[188:189], v[182:183]
    v_exp_f32 v128, v128
    v_exp_f32 v129, v129
    v_exp_f32 v130, v130
    v_exp_f32 v131, v131
    v_pk_fma_f32 v[132:133], v[132:133], v[188:189], v[182:183]
    v_pk_fma_f32 v[134:135], v[134:135], v[188:189], v[182:183]
    v_exp_f32 v132, v132
    v_exp_f32 v133, v133
    v_exp_f32 v134, v134
    v_exp_f32 v135, v135
    v_pk_fma_f32 v[136:137], v[136:137], v[188:189], v[182:183]
    v_pk_fma_f32 v[138:139], v[138:139], v[188:189], v[182:183]
    v_exp_f32 v136, v136
    v_exp_f32 v137, v137
    v_exp_f32 v138, v138
    v_exp_f32 v139, v139
    v_pk_fma_f32 v[140:141], v[140:141], v[188:189], v[182:183]
    v_pk_fma_f32 v[142:143], v[142:143], v[188:189], v[182:183]
    v_exp_f32 v140, v140
    v_exp_f32 v141, v141
    v_exp_f32 v142, v142
    v_exp_f32 v143, v143
    v_pk_fma_f32 v[144:145], v[144:145], v[188:189], v[182:183]
    v_pk_fma_f32 v[146:147], v[146:147], v[188:189], v[182:183]
    v_exp_f32 v144, v144
    v_exp_f32 v145, v145
    v_exp_f32 v146, v146
    v_exp_f32 v147, v147
    v_pk_fma_f32 v[148:149], v[148:149], v[188:189], v[182:183]
    v_pk_fma_f32 v[150:151], v[150:151], v[188:189], v[182:183]
    v_exp_f32 v148, v148
    v_exp_f32 v149, v149
    v_exp_f32 v150, v150
    v_exp_f32 v151, v151
    v_pk_fma_f32 v[152:153], v[152:153], v[188:189], v[182:183]
    v_pk_fma_f32 v[154:155], v[154:155], v[188:189], v[182:183]
    v_exp_f32 v152, v152
    v_exp_f32 v153, v153
    v_exp_f32 v154, v154
    v_exp_f32 v155, v155
    v_pk_fma_f32 v[156:157], v[156:157], v[188:189], v[182:183]
    v_pk_fma_f32 v[158:159], v[158:159], v[188:189], v[182:183]
    v_exp_f32 v156, v156
    v_exp_f32 v157, v157
    v_exp_f32 v158, v158
    v_exp_f32 v159, v159
    s_nop 0
    v_cvt_pk_bf16_f32 v16, v16, v17
    v_cvt_pk_bf16_f32 v17, v18, v19
    v_cvt_pk_bf16_f32 v18, v20, v21
    v_cvt_pk_bf16_f32 v19, v22, v23
    v_cvt_pk_bf16_f32 v24, v24, v25
    v_cvt_pk_bf16_f32 v25, v26, v27
    v_cvt_pk_bf16_f32 v26, v28, v29
    v_cvt_pk_bf16_f32 v27, v30, v31
    v_cvt_pk_bf16_f32 v32, v32, v33
    v_cvt_pk_bf16_f32 v33, v34, v35
    v_cvt_pk_bf16_f32 v34, v36, v37
    v_cvt_pk_bf16_f32 v35, v38, v39
    v_cvt_pk_bf16_f32 v40, v40, v41
    v_cvt_pk_bf16_f32 v41, v42, v43
    v_cvt_pk_bf16_f32 v42, v44, v45
    v_cvt_pk_bf16_f32 v43, v46, v47
    v_cvt_pk_bf16_f32 v48, v48, v49
    v_cvt_pk_bf16_f32 v49, v50, v51
    v_cvt_pk_bf16_f32 v50, v52, v53
    v_cvt_pk_bf16_f32 v51, v54, v55
    v_cvt_pk_bf16_f32 v56, v56, v57
    v_cvt_pk_bf16_f32 v57, v58, v59
    v_cvt_pk_bf16_f32 v58, v60, v61
    v_cvt_pk_bf16_f32 v59, v62, v63
    v_cvt_pk_bf16_f32 v64, v64, v65
    v_cvt_pk_bf16_f32 v65, v66, v67
    v_cvt_pk_bf16_f32 v66, v68, v69
    v_cvt_pk_bf16_f32 v67, v70, v71
    v_cvt_pk_bf16_f32 v72, v72, v73
    v_cvt_pk_bf16_f32 v73, v74, v75
    v_cvt_pk_bf16_f32 v74, v76, v77
    v_cvt_pk_bf16_f32 v75, v78, v79
    v_cvt_pk_bf16_f32 v80, v80, v81
    v_cvt_pk_bf16_f32 v81, v82, v83
    v_mov_b32 v82, 0
    v_mov_b32 v83, 0
    v_cvt_pk_bf16_f32 v90, v92, v93
    v_cvt_pk_bf16_f32 v91, v94, v95
    v_mov_b32 v88, 0
    v_mov_b32 v89, 0
    v_cvt_pk_bf16_f32 v96, v96, v97
    v_cvt_pk_bf16_f32 v97, v98, v99
    v_cvt_pk_bf16_f32 v98, v100, v101
    v_cvt_pk_bf16_f32 v99, v102, v103
    v_cvt_pk_bf16_f32 v104, v104, v105
    v_cvt_pk_bf16_f32 v105, v106, v107
    v_cvt_pk_bf16_f32 v106, v108, v109
    v_cvt_pk_bf16_f32 v107, v110, v111
    v_cvt_pk_bf16_f32 v112, v112, v113
    v_cvt_pk_bf16_f32 v113, v114, v115
    v_cvt_pk_bf16_f32 v114, v116, v117
    v_cvt_pk_bf16_f32 v115, v118, v119
    v_cvt_pk_bf16_f32 v120, v120, v121
    v_cvt_pk_bf16_f32 v121, v122, v123
    v_cvt_pk_bf16_f32 v122, v124, v125
    v_cvt_pk_bf16_f32 v123, v126, v127
    v_cvt_pk_bf16_f32 v128, v128, v129
    v_cvt_pk_bf16_f32 v129, v130, v131
    v_cvt_pk_bf16_f32 v130, v132, v133
    v_cvt_pk_bf16_f32 v131, v134, v135
    v_cvt_pk_bf16_f32 v136, v136, v137
    v_cvt_pk_bf16_f32 v137, v138, v139
    v_cvt_pk_bf16_f32 v138, v140, v141
    v_cvt_pk_bf16_f32 v139, v142, v143
    v_cvt_pk_bf16_f32 v144, v144, v145
    v_cvt_pk_bf16_f32 v145, v146, v147
    v_cvt_pk_bf16_f32 v146, v148, v149
    v_cvt_pk_bf16_f32 v147, v150, v151
    v_cvt_pk_bf16_f32 v152, v152, v153
    v_cvt_pk_bf16_f32 v153, v154, v155
    v_cvt_pk_bf16_f32 v154, v156, v157
    v_cvt_pk_bf16_f32 v155, v158, v159
    s_waitcnt vmcnt(0)
    s_nop 1
    v_mfma_f32_16x16x32_bf16 v[160:163], a[72:75], v[16:19], 0
    v_mfma_f32_16x16x32_bf16 v[164:167], a[76:79], v[16:19], 0
    v_mfma_f32_16x16x32_bf16 v[168:171], a[72:75], v[88:91], 0
    v_mfma_f32_16x16x32_bf16 v[172:175], a[76:79], v[88:91], 0
    v_mfma_f32_16x16x32_bf16 v[160:163], a[80:83], v[24:27], v[160:163]
    v_mfma_f32_16x16x32_bf16 v[164:167], a[84:87], v[24:27], v[164:167]
    v_mfma_f32_16x16x32_bf16 v[168:171], a[80:83], v[96:99], v[168:171]
    v_mfma_f32_16x16x32_bf16 v[172:175], a[84:87], v[96:99], v[172:175]
    v_mfma_f32_16x16x32_bf16 v[160:163], a[88:91], v[32:35], v[160:163]
    v_mfma_f32_16x16x32_bf16 v[164:167], a[92:95], v[32:35], v[164:167]
    v_mfma_f32_16x16x32_bf16 v[168:171], a[88:91], v[104:107], v[168:171]
    v_mfma_f32_16x16x32_bf16 v[172:175], a[92:95], v[104:107], v[172:175]
    v_mfma_f32_16x16x32_bf16 v[160:163], a[96:99], v[40:43], v[160:163]
    v_mfma_f32_16x16x32_bf16 v[164:167], a[100:103], v[40:43], v[164:167]
    v_mfma_f32_16x16x32_bf16 v[168:171], a[96:99], v[112:115], v[168:171]
    v_mfma_f32_16x16x32_bf16 v[172:175], a[100:103], v[112:115], v[172:175]
    v_mfma_f32_16x16x32_bf16 v[160:163], a[104:107], v[48:51], v[160:163]
    v_mfma_f32_16x16x32_bf16 v[164:167], a[108:111], v[48:51], v[164:167]
    v_mfma_f32_16x16x32_bf16 v[168:171], a[104:107], v[120:123], v[168:171]
    v_mfma_f32_16x16x32_bf16 v[172:175], a[108:111], v[120:123], v[172:175]
    v_mfma_f32_16x16x32_bf16 v[160:163], a[112:115], v[56:59], v[160:163]
    v_mfma_f32_16x16x32_bf16 v[164:167], a[116:119], v[56:59], v[164:167]
    v_mfma_f32_16x16x32_bf16 v[168:171], a[112:115], v[128:131], v[168:171]
    v_mfma_f32_16x16x32_bf16 v[172:175], a[116:119], v[128:131], v[172:175]
    v_mfma_f32_16x16x32_bf16 v[160:163], a[120:123], v[64:67], v[160:163]
    v_mfma_f32_16x16x32_bf16 v[164:167], a[124:127], v[64:67], v[164:167]
    v_mfma_f32_16x16x32_bf16 v[168:171], a[120:123], v[136:139], v[168:171]
    v_mfma_f32_16x16x32_bf16 v[172:175], a[124:127], v[136:139], v[172:175]
    v_mfma_f32_16x16x32_bf16 v[160:163], a[128:131], v[72:75], v[160:163]
    v_mfma_f32_16x16x32_bf16 v[164:167], a[132:135], v[72:75], v[164:167]
    v_mfma_f32_16x16x32_bf16 v[168:171], a[128:131], v[144:147], v[168:171]
    v_mfma_f32_16x16x32_bf16 v[172:175], a[132:135], v[144:147], v[172:175]
    v_mfma_f32_16x16x32_bf16 v[160:163], a[136:139], v[80:83], v[160:163]
    v_mfma_f32_16x16x32_bf16 v[164:167], a[140:143], v[80:83], v[164:167]
    v_mfma_f32_16x16x32_bf16 v[168:171], a[136:139], v[152:155], v[168:171]
    v_mfma_f32_16x16x32_bf16 v[172:175], a[140:143], v[152:155], v[172:175]
    v_add_u32 v7, 48, v3
    v_lshlrev_b32 v7, 2, v7
    s_nop 7
    ds_bpermute_b32 v176, v7, v164
    ds_bpermute_b32 v177, v7, v172
    s_waitcnt lgkmcnt(0)
    v_rcp_f32 v176, v176
    v_rcp_f32 v177, v177
    s_nop 0
    s_lshl_b32 s12, s11, 15
    s_lshl_b32 s13, s37, 10
    s_add_u32 s12, s12, s13
    s_add_u32 s12, s12, 0xb00000
    s_add_u32 s13, s12, 16384
    v_mul_f32 v160, v176, v160
    v_mul_f32 v161, v176, v161
    v_mul_f32 v162, v176, v162
    v_mul_f32 v163, v176, v163
    v_mul_f32 v164, v176, v164
    v_mul_f32 v165, v176, v165
    v_mul_f32 v166, v176, v166
    v_mul_f32 v167, v176, v167
    v_cvt_pk_bf16_f32 v180, v160, v161
    v_cvt_pk_bf16_f32 v181, v162, v163
    v_cvt_pk_bf16_f32 v182, v164, v165
    v_cvt_pk_bf16_f32 v183, v166, v167
    buffer_store_dwordx4 v[180:183], v5, s[52:55], s12 offen sc0 sc1
    v_mul_f32 v168, v177, v168
    v_mul_f32 v169, v177, v169
    v_mul_f32 v170, v177, v170
    v_mul_f32 v171, v177, v171
    v_mul_f32 v172, v177, v172
    v_mul_f32 v173, v177, v173
    v_mul_f32 v174, v177, v174
    v_mul_f32 v175, v177, v175
    v_cvt_pk_bf16_f32 v184, v168, v169
    v_cvt_pk_bf16_f32 v185, v170, v171
    v_cvt_pk_bf16_f32 v186, v172, v173
    v_cvt_pk_bf16_f32 v187, v174, v175
    buffer_store_dwordx4 v[184:187], v5, s[52:55], s13 offen sc0 sc1
    s_lshl_b32 s41, s36, 9
    s_add_u32 s41, s41, 0x440000
    s_waitcnt vmcnt(0)
    s_barrier
    s_cmp_lg_u32 s3, 0
    s_cbranch_scc1 L_sig_28
    s_mov_b64 exec, 1
    v_mov_b32 v254, 1
    v_mov_b32 v255, 0
    buffer_atomic_add v254, v255, s[52:55], s41 offen sc1
    s_mov_b64 exec, -1
L_sig_28:
    s_cmp_ge_u32 s37, 14
    s_cbranch_scc1 L_mega_skip
    s_cmp_ge_u32 s37, 7
    s_cselect_b32 s10, 1, 0
    s_mul_i32 s11, s10, 7
    s_sub_u32 s11, s37, s11
    s_lshl_b32 s8, s36, 1
    s_add_u32 s10, s10, s8
    s_mul_i32 s12, s10, 65536
    s_mul_i32 s13, s3, 4096
    s_add_u32 s12, s12, s13
    s_add_u32 s12, s12, 0xb00000
    s_add_u32 s13, s12, 16384
    s_add_u32 s14, s12, 32768
    s_add_u32 s15, s12, 49152
    s_mul_i32 s16, s11, 65536
    s_mul_i32 s20, s3, 4096
    s_add_u32 s16, s16, s20
    s_add_u32 s16, s16, 0xa00000
    s_add_u32 s17, s16, 16384
    s_add_u32 s18, s16, 32768
    s_add_u32 s19, s16, 49152
    s_lshl_b32 s20, s10, 2
    s_add_u32 s20, s20, s3
    s_mul_i32 s21, s20, 14336
    s_lshl_b32 s22, s11, 11
    s_add_u32 s21, s21, s22
    s_add_u32 s24, s21, 0x200000
    s_add_u32 s21, s21, 0x0
    buffer_load_dwordx4 a[16:19], v5, s[4:7], s16 offen offset:0
    buffer_load_dwordx4 a[20:23], v5, s[4:7], s17 offen offset:0
    buffer_load_dwordx4 a[24:27], v5, s[4:7], s18 offen offset:0
    buffer_load_dwordx4 a[28:31], v5, s[4:7], s19 offen offset:0
    buffer_load_dwordx4 a[48:51], v5, s[4:7], s16 offen offset:1024
    buffer_load_dwordx4 a[52:55], v5, s[4:7], s17 offen offset:1024
    buffer_load_dwordx4 a[56:59], v5, s[4:7], s18 offen offset:1024
    buffer_load_dwordx4 a[60:63], v5, s[4:7], s19 offen offset:1024
    buffer_load_dwordx4 a[80:83], v5, s[4:7], s16 offen offset:2048
    buffer_load_dwordx4 a[84:87], v5, s[4:7], s17 offen offset:2048
    buffer_load_dwordx4 a[88:91], v5, s[4:7], s18 offen offset:2048
    buffer_load_dwordx4 a[92:95], v5, s[4:7], s19 offen offset:2048
    buffer_load_dwordx4 a[112:115], v5, s[4:7], s16 offen offset:3072
    buffer_load_dwordx4 a[116:119], v5, s[4:7], s17 offen offset:3072
    buffer_load_dwordx4 a[120:123], v5, s[4:7], s18 offen offset:3072
    buffer_load_dwordx4 a[124:127], v5, s[4:7], s19 offen offset:3072
    s_add_u32 s16, s16, 4096
    s_add_u32 s17, s17, 4096
    s_add_u32 s18, s18, 4096
    s_add_u32 s19, s19, 4096
    buffer_load_dwordx4 v[8:11], v5, s[52:55], s21 offen
    buffer_load_dwordx4 v[12:15], v5, s[52:55], s21 offen offset:1024
    s_lshl_b32 s41, s36, 9
    s_add_u32 s41, s41, 0x440000
    s_cmp_lg_u32 s3, 0
    s_cbranch_scc1 L_wdone_29
    s_mov_b32 s42, 0x40000
    v_mov_b32 v255, 0
L_wloop_30:
    buffer_load_dword v254, v255, s[52:55], s41 offen sc0 sc1
    s_waitcnt vmcnt(0)
    v_readfirstlane_b32 s43, v254
    s_cmp_ge_u32 s43, 16
    s_cbranch_scc1 L_wdone_29
    s_sub_u32 s42, s42, 1
    s_cmp_eq_u32 s42, 0
    s_cbranch_scc1 L_wdone_29
    s_sleep 1
    s_branch L_wloop_30
L_wdone_29:
    s_barrier
    buffer_load_dwordx4 a[0:3], v5, s[52:55], s12 offen offset:0
    buffer_load_dwordx4 a[4:7], v5, s[52:55], s13 offen offset:0
    buffer_load_dwordx4 a[8:11], v5, s[52:55], s14 offen offset:0
    buffer_load_dwordx4 a[12:15], v5, s[52:55], s15 offen offset:0
    buffer_load_dwordx4 a[32:35], v5, s[52:55], s12 offen offset:1024
    buffer_load_dwordx4 a[36:39], v5, s[52:55], s13 offen offset:1024
    buffer_load_dwordx4 a[40:43], v5, s[52:55], s14 offen offset:1024
    buffer_load_dwordx4 a[44:47], v5, s[52:55], s15 offen offset:1024
    buffer_load_dwordx4 a[64:67], v5, s[52:55], s12 offen offset:2048
    buffer_load_dwordx4 a[68:71], v5, s[52:55], s13 offen offset:2048
    buffer_load_dwordx4 a[72:75], v5, s[52:55], s14 offen offset:2048
    buffer_load_dwordx4 a[76:79], v5, s[52:55], s15 offen offset:2048
    buffer_load_dwordx4 a[96:99], v5, s[52:55], s12 offen offset:3072
    buffer_load_dwordx4 a[100:103], v5, s[52:55], s13 offen offset:3072
    buffer_load_dwordx4 a[104:107], v5, s[52:55], s14 offen offset:3072
    buffer_load_dwordx4 a[108:111], v5, s[52:55], s15 offen offset:3072
    s_add_u32 s12, s12, 4096
    s_add_u32 s13, s13, 4096
    s_add_u32 s14, s14, 4096
    s_add_u32 s15, s15, 4096
    s_waitcnt vmcnt(12)
    v_mfma_f32_16x16x32_bf16 v[16:19], a[16:19], a[0:3], 0
    v_mfma_f32_16x16x32_bf16 v[20:23], a[20:23], a[0:3], 0
    v_mfma_f32_16x16x32_bf16 v[24:27], a[24:27], a[0:3], 0
    v_mfma_f32_16x16x32_bf16 v[28:31], a[28:31], a[0:3], 0
    v_mfma_f32_16x16x32_bf16 v[32:35], a[16:19], a[4:7], 0
    v_mfma_f32_16x16x32_bf16 v[36:39], a[20:23], a[4:7], 0
    v_mfma_f32_16x16x32_bf16 v[40:43], a[24:27], a[4:7], 0
    v_mfma_f32_16x16x32_bf16 v[44:47], a[28:31], a[4:7], 0
    v_mfma_f32_16x16x32_bf16 v[48:51], a[16:19], a[8:11], 0
    v_mfma_f32_16x16x32_bf16 v[52:55], a[20:23], a[8:11], 0
    v_mfma_f32_16x16x32_bf16 v[56:59], a[24:27], a[8:11], 0
    v_mfma_f32_16x16x32_bf16 v[60:63], a[28:31], a[8:11], 0
    v_mfma_f32_16x16x32_bf16 v[64:67], a[16:19], a[12:15], 0
    v_mfma_f32_16x16x32_bf16 v[68:71], a[20:23], a[12:15], 0
    v_mfma_f32_16x16x32_bf16 v[72:75], a[24:27], a[12:15], 0
    v_mfma_f32_16x16x32_bf16 v[76:79], a[28:31], a[12:15], 0
    s_waitcnt vmcnt(8)
    v_mfma_f32_16x16x32_bf16 v[16:19], a[48:51], a[32:35], v[16:19]
    v_mfma_f32_16x16x32_bf16 v[20:23], a[52:55], a[32:35], v[20:23]
    v_mfma_f32_16x16x32_bf16 v[24:27], a[56:59], a[32:35], v[24:27]
    v_mfma_f32_16x16x32_bf16 v[28:31], a[60:63], a[32:35], v[28:31]
    v_mfma_f32_16x16x32_bf16 v[32:35], a[48:51], a[36:39], v[32:35]
    v_mfma_f32_16x16x32_bf16 v[36:39], a[52:55], a[36:39], v[36:39]
    v_mfma_f32_16x16x32_bf16 v[40:43], a[56:59], a[36:39], v[40:43]
    v_mfma_f32_16x16x32_bf16 v[44:47], a[60:63], a[36:39], v[44:47]
    v_mfma_f32_16x16x32_bf16 v[48:51], a[48:51], a[40:43], v[48:51]
    v_mfma_f32_16x16x32_bf16 v[52:55], a[52:55], a[40:43], v[52:55]
    v_mfma_f32_16x16x32_bf16 v[56:59], a[56:59], a[40:43], v[56:59]
    v_mfma_f32_16x16x32_bf16 v[60:63], a[60:63], a[40:43], v[60:63]
    v_mfma_f32_16x16x32_bf16 v[64:67], a[48:51], a[44:47], v[64:67]
    v_mfma_f32_16x16x32_bf16 v[68:71], a[52:55], a[44:47], v[68:71]
    v_mfma_f32_16x16x32_bf16 v[72:75], a[56:59], a[44:47], v[72:75]
    v_mfma_f32_16x16x32_bf16 v[76:79], a[60:63], a[44:47], v[76:79]
    s_waitcnt vmcnt(4)
    v_mfma_f32_16x16x32_bf16 v[16:19], a[80:83], a[64:67], v[16:19]
    v_mfma_f32_16x16x32_bf16 v[20:23], a[84:87], a[64:67], v[20:23]
    v_mfma_f32_16x16x32_bf16 v[24:27], a[88:91], a[64:67], v[24:27]
    v_mfma_f32_16x16x32_bf16 v[28:31], a[92:95], a[64:67], v[28:31]
    v_mfma_f32_16x16x32_bf16 v[32:35], a[80:83], a[68:71], v[32:35]
    v_mfma_f32_16x16x32_bf16 v[36:39], a[84:87], a[68:71], v[36:39]
    v_mfma_f32_16x16x32_bf16 v[40:43], a[88:91], a[68:71], v[40:43]
    v_mfma_f32_16x16x32_bf16 v[44:47], a[92:95], a[68:71], v[44:47]
    v_mfma_f32_16x16x32_bf16 v[48:51], a[80:83], a[72:75], v[48:51]
    v_mfma_f32_16x16x32_bf16 v[52:55], a[84:87], a[72:75], v[52:55]
    v_mfma_f32_16x16x32_bf16 v[56:59], a[88:91], a[72:75], v[56:59]
    v_mfma_f32_16x16x32_bf16 v[60:63], a[92:95], a[72:75], v[60:63]
    v_mfma_f32_16x16x32_bf16 v[64:67], a[80:83], a[76:79], v[64:67]
    v_mfma_f32_16x16x32_bf16 v[68:71], a[84:87], a[76:79], v[68:71]
    v_mfma_f32_16x16x32_bf16 v[72:75], a[88:91], a[76:79], v[72:75]
    v_mfma_f32_16x16x32_bf16 v[76:79], a[92:95], a[76:79], v[76:79]
    s_waitcnt vmcnt(0)
    v_mfma_f32_16x16x32_bf16 v[16:19], a[112:115], a[96:99], v[16:19]
    v_mfma_f32_16x16x32_bf16 v[20:23], a[116:119], a[96:99], v[20:23]
    v_mfma_f32_16x16x32_bf16 v[24:27], a[120:123], a[96:99], v[24:27]
    v_mfma_f32_16x16x32_bf16 v[28:31], a[124:127], a[96:99], v[28:31]
    v_mfma_f32_16x16x32_bf16 v[32:35], a[112:115], a[100:103], v[32:35]
    v_mfma_f32_16x16x32_bf16 v[36:39], a[116:119], a[100:103], v[36:39]
    v_mfma_f32_16x16x32_bf16 v[40:43], a[120:123], a[100:103], v[40:43]
    v_mfma_f32_16x16x32_bf16 v[44:47], a[124:127], a[100:103], v[44:47]
    v_mfma_f32_16x16x32_bf16 v[48:51], a[112:115], a[104:107], v[48:51]
    v_mfma_f32_16x16x32_bf16 v[52:55], a[116:119], a[104:107], v[52:55]
    v_mfma_f32_16x16x32_bf16 v[56:59], a[120:123], a[104:107], v[56:59]
    v_mfma_f32_16x16x32_bf16 v[60:63], a[124:127], a[104:107], v[60:63]
    v_mfma_f32_16x16x32_bf16 v[64:67], a[112:115], a[108:111], v[64:67]
    v_mfma_f32_16x16x32_bf16 v[68:71], a[116:119], a[108:111], v[68:71]
    v_mfma_f32_16x16x32_bf16 v[72:75], a[120:123], a[108:111], v[72:75]
    v_mfma_f32_16x16x32_bf16 v[76:79], a[124:127], a[108:111], v[76:79]
    s_nop 7
    s_lshl_b32 s22, s3, 14
    v_add_u32 v6, s22, v5
    ds_write_b128 v6, v[16:19] offset:0
    ds_write_b128 v6, v[20:23] offset:1024
    ds_write_b128 v6, v[24:27] offset:2048
    ds_write_b128 v6, v[28:31] offset:3072
    ds_write_b128 v6, v[32:35] offset:4096
    ds_write_b128 v6, v[36:39] offset:5120
    ds_write_b128 v6, v[40:43] offset:6144
    ds_write_b128 v6, v[44:47] offset:7168
    ds_write_b128 v6, v[48:51] offset:8192
    ds_write_b128 v6, v[52:55] offset:9216
    ds_write_b128 v6, v[56:59] offset:10240
    ds_write_b128 v6, v[60:63] offset:11264
    ds_write_b128 v6, v[64:67] offset:12288
    ds_write_b128 v6, v[68:71] offset:13312
    ds_write_b128 v6, v[72:75] offset:14336
    ds_write_b128 v6, v[76:79] offset:15360
    s_waitcnt lgkmcnt(0)
    s_barrier
    s_lshl_b32 s22, s3, 12
    v_add_u32 v6, s22, v5
    ds_read_b128 v[80:83], v6 offset:0
    ds_read_b128 v[84:87], v6 offset:1024
    ds_read_b128 v[88:91], v6 offset:2048
    ds_read_b128 v[92:95], v6 offset:3072
    ds_read_b128 v[96:99], v6 offset:16384
    ds_read_b128 v[100:103], v6 offset:17408
    ds_read_b128 v[104:107], v6 offset:18432
    ds_read_b128 v[108:111], v6 offset:19456
    ds_read_b128 v[112:115], v6 offset:32768
    ds_read_b128 v[116:119], v6 offset:33792
    ds_read_b128 v[120:123], v6 offset:34816
    ds_read_b128 v[124:127], v6 offset:35840
    ds_read_b128 v[128:131], v6 offset:49152
    ds_read_b128 v[132:135], v6 offset:50176
    ds_read_b128 v[136:139], v6 offset:51200
    ds_read_b128 v[140:143], v6 offset:52224
    s_waitcnt lgkmcnt(8)
    v_pk_add_f32 v[80:81], v[80:81], v[96:97]
    v_pk_add_f32 v[82:83], v[82:83], v[98:99]
    v_pk_add_f32 v[84:85], v[84:85], v[100:101]
    v_pk_add_f32 v[86:87], v[86:87], v[102:103]
    v_pk_add_f32 v[88:89], v[88:89], v[104:105]
    v_pk_add_f32 v[90:91], v[90:91], v[106:107]
    v_pk_add_f32 v[92:93], v[92:93], v[108:109]
    v_pk_add_f32 v[94:95], v[94:95], v[110:111]
    s_waitcnt lgkmcnt(0)
    v_pk_add_f32 v[112:113], v[112:113], v[128:129]
    v_pk_add_f32 v[114:115], v[114:115], v[130:131]
    v_pk_add_f32 v[116:117], v[116:117], v[132:133]
    v_pk_add_f32 v[118:119], v[118:119], v[134:135]
    v_pk_add_f32 v[120:121], v[120:121], v[136:137]
    v_pk_add_f32 v[122:123], v[122:123], v[138:139]
    v_pk_add_f32 v[124:125], v[124:125], v[140:141]
    v_pk_add_f32 v[126:127], v[126:127], v[142:143]
    v_pk_add_f32 v[80:81], v[80:81], v[112:113]
    v_pk_add_f32 v[82:83], v[82:83], v[114:115]
    v_pk_add_f32 v[84:85], v[84:85], v[116:117]
    v_pk_add_f32 v[86:87], v[86:87], v[118:119]
    v_pk_add_f32 v[88:89], v[88:89], v[120:121]
    v_pk_add_f32 v[90:91], v[90:91], v[122:123]
    v_pk_add_f32 v[92:93], v[92:93], v[124:125]
    v_pk_add_f32 v[94:95], v[94:95], v[126:127]
    v_cvt_pk_bf16_f32 v16, v80, v81
    v_cvt_pk_bf16_f32 v17, v82, v83
    v_cvt_pk_bf16_f32 v18, v84, v85
    v_cvt_pk_bf16_f32 v19, v86, v87
    v_cvt_pk_bf16_f32 v20, v88, v89
    v_cvt_pk_bf16_f32 v21, v90, v91
    v_cvt_pk_bf16_f32 v22, v92, v93
    v_cvt_pk_bf16_f32 v23, v94, v95
    v_lshlrev_b32 v32, 16, v16
    v_and_b32 v33, 0xffff0000, v16
    v_lshlrev_b32 v48, 16, v8
    v_and_b32 v49, 0xffff0000, v8
    v_lshlrev_b32 v34, 16, v17
    v_and_b32 v35, 0xffff0000, v17
    v_lshlrev_b32 v50, 16, v9
    v_and_b32 v51, 0xffff0000, v9
    v_lshlrev_b32 v36, 16, v18
    v_and_b32 v37, 0xffff0000, v18
    v_lshlrev_b32 v52, 16, v10
    v_and_b32 v53, 0xffff0000, v10
    v_lshlrev_b32 v38, 16, v19
    v_and_b32 v39, 0xffff0000, v19
    v_lshlrev_b32 v54, 16, v11
    v_and_b32 v55, 0xffff0000, v11
    v_lshlrev_b32 v40, 16, v20
    v_and_b32 v41, 0xffff0000, v20
    v_lshlrev_b32 v56, 16, v12
    v_and_b32 v57, 0xffff0000, v12
    v_lshlrev_b32 v42, 16, v21
    v_and_b32 v43, 0xffff0000, v21
    v_lshlrev_b32 v58, 16, v13
    v_and_b32 v59, 0xffff0000, v13
    v_lshlrev_b32 v44, 16, v22
    v_and_b32 v45, 0xffff0000, v22
    v_lshlrev_b32 v60, 16, v14
    v_and_b32 v61, 0xffff0000, v14
    v_lshlrev_b32 v46, 16, v23
    v_and_b32 v47, 0xffff0000, v23
    v_lshlrev_b32 v62, 16, v15
    v_and_b32 v63, 0xffff0000, v15
    v_pk_add_f32 v[32:33], v[32:33], v[48:49]
    v_pk_add_f32 v[34:35], v[34:35], v[50:51]
    v_pk_add_f32 v[36:37], v[36:37], v[52:53]
    v_pk_add_f32 v[38:39], v[38:39], v[54:55]
    v_pk_add_f32 v[40:41], v[40:41], v[56:57]
    v_pk_add_f32 v[42:43], v[42:43], v[58:59]
    v_pk_add_f32 v[44:45], v[44:45], v[60:61]
    v_pk_add_f32 v[46:47], v[46:47], v[62:63]
    v_cvt_pk_bf16_f32 v24, v32, v33
    v_cvt_pk_bf16_f32 v25, v34, v35
    v_cvt_pk_bf16_f32 v26, v36, v37
    v_cvt_pk_bf16_f32 v27, v38, v39
    v_cvt_pk_bf16_f32 v28, v40, v41
    v_cvt_pk_bf16_f32 v29, v42, v43
    v_cvt_pk_bf16_f32 v30, v44, v45
    v_cvt_pk_bf16_f32 v31, v46, v47
    buffer_store_dwordx4 v[24:27], v5, s[52:55], s24 offen sc0 sc1
    buffer_store_dwordx4 v[28:31], v5, s[52:55], s24 offen offset:1024 sc0 sc1
    v_mov_b32 v64, 0
    v_mov_b32 v65, 0
    v_mov_b32 v66, 0
    v_mov_b32 v67, 0
    v_dot2c_f32_bf16 v64, s40, v24
    v_dot2c_f32_bf16 v65, v24, v24
    v_dot2c_f32_bf16 v66, s40, v25
    v_dot2c_f32_bf16 v67, v25, v25
    v_dot2c_f32_bf16 v64, s40, v26
    v_dot2c_f32_bf16 v65, v26, v26
    v_dot2c_f32_bf16 v66, s40, v27
    v_dot2c_f32_bf16 v67, v27, v27
    v_dot2c_f32_bf16 v64, s40, v28
    v_dot2c_f32_bf16 v65, v28, v28
    v_dot2c_f32_bf16 v66, s40, v29
    v_dot2c_f32_bf16 v67, v29, v29
    v_dot2c_f32_bf16 v64, s40, v30
    v_dot2c_f32_bf16 v65, v30, v30
    v_dot2c_f32_bf16 v66, s40, v31
    v_dot2c_f32_bf16 v67, v31, v31
    s_lshl_b32 s22, s20, 7
    s_lshl_b32 s23, s11, 14
    s_add_u32 s22, s22, s23
    s_add_u32 s22, s22, 0x420000
    v_lshlrev_b32 v6, 3, v3
    v_pk_add_f32 v[64:65], v[64:65], v[66:67]
    v_mov_b32 v66, v64
    v_mov_b32 v67, v65
    s_nop 1
    v_permlane16_swap_b32 v64, v66
    v_permlane16_swap_b32 v65, v67
    v_add_f32 v64, v64, v66
    v_add_f32 v65, v65, v67
    v_mov_b32 v66, v64
    v_mov_b32 v67, v65
    s_nop 1
    v_permlane32_swap_b32 v64, v66
    v_permlane32_swap_b32 v65, v67
    v_add_f32 v64, v64, v66
    v_add_f32 v65, v65, v67
    buffer_store_dwordx2 v[64:65], v6, s[52:55], s22 offen sc0 sc1
    s_lshl_b32 s41, s36, 9
    s_add_u32 s41, s41, 0x440080
    s_waitcnt vmcnt(0)
    s_barrier
    s_cmp_lg_u32 s3, 0
    s_cbranch_scc1 L_sig_31
    s_mov_b64 exec, 1
    v_mov_b32 v254, 1
    v_mov_b32 v255, 0
    buffer_atomic_add v254, v255, s[52:55], s41 offen sc1
    s_mov_b64 exec, -1
L_sig_31:
    s_lshl_b32 s12, s36, 3
    s_lshl_b32 s13, s3, 1
    s_add_u32 s12, s12, s13
    s_mul_i32 s14, s12, 14336
    s_add_u32 s14, s14, 0x200000
    s_add_u32 s15, s14, 14336
    s_lshl_b32 s16, s3, 11
    s_lshl_b32 s17, s37, 2
    s_add_u32 s17, s17, s3
    s_mul_i32 s18, s17, 57344
    s_add_u32 s18, s18, 0xb00000
    v_add_u32 v7, 0x10000, v5
    s_lshl_b32 s23, s17, 7
    s_add_u32 s24, s23, 0x1104000
    s_add_u32 s23, s23, 0x1102000
    v_lshlrev_b32 v6, 4, v4
    buffer_load_dwordx4 v[200:203], v6, s[4:7], s23 offen offset:0
    buffer_load_dwordx4 v[204:207], v6, s[4:7], s23 offen offset:64
    buffer_load_dwordx4 v[208:211], v6, s[4:7], s24 offen offset:0
    buffer_load_dwordx4 v[212:215], v6, s[4:7], s24 offen offset:64
    s_add_u32 s23, s23, 0x8000
    s_add_u32 s24, s24, 0x8000
    buffer_load_dwordx4 v[64:67], v6, s[4:7], s23 offen offset:0
    buffer_load_dwordx4 v[68:71], v6, s[4:7], s23 offen offset:64
    buffer_load_dwordx4 v[72:75], v6, s[4:7], s24 offen offset:0
    buffer_load_dwordx4 v[76:79], v6, s[4:7], s24 offen offset:64
    s_add_u32 s23, s23, 0x8000
    s_add_u32 s24, s24, 0x8000
    buffer_load_dwordx4 v[80:83], v6, s[4:7], s23 offen offset:0
    buffer_load_dwordx4 v[84:87], v6, s[4:7], s23 offen offset:64
    buffer_load_dwordx4 v[88:91], v6, s[4:7], s24 offen offset:0
    buffer_load_dwordx4 v[92:95], v6, s[4:7], s24 offen offset:64
    s_add_u32 s23, s23, 0x8000
    s_add_u32 s24, s24, 0x8000
    buffer_load_dwordx4 v[96:99], v6, s[4:7], s23 offen offset:0
    buffer_load_dwordx4 v[100:103], v6, s[4:7], s23 offen offset:64
    buffer_load_dwordx4 v[104:107], v6, s[4:7], s24 offen offset:0
    buffer_load_dwordx4 v[108:111], v6, s[4:7], s24 offen offset:64
    s_add_u32 s23, s23, 0x8000
    s_add_u32 s24, s24, 0x8000
    buffer_load_dwordx4 a[0:3], v5, s[4:7], s18 offen offset:0
    buffer_load_dwordx4 a[4:7], v5, s[4:7], s18 offen offset:1024
    buffer_load_dwordx4 a[8:11], v5, s[4:7], s18 offen offset:2048
    buffer_load_dwordx4 a[12:15], v5, s[4:7], s18 offen offset:3072
    s_add_u32 s18, s18, 4096
    buffer_load_dwordx4 a[16:19], v5, s[4:7], s18 offen offset:0
    buffer_load_dwordx4 a[20:23], v5, s[4:7], s18 offen offset:1024
    buffer_load_dwordx4 a[24:27], v5, s[4:7], s18 offen offset:2048
    buffer_load_dwordx4 a[28:31], v5, s[4:7], s18 offen offset:3072
    s_add_u32 s18, s18, 4096
    buffer_load_dwordx4 a[32:35], v5, s[4:7], s18 offen offset:0
    buffer_load_dwordx4 a[36:39], v5, s[4:7], s18 offen offset:1024
    buffer_load_dwordx4 a[40:43], v5, s[4:7], s18 offen offset:2048
    buffer_load_dwordx4 a[44:47], v5, s[4:7], s18 offen offset:3072
    s_add_u32 s18, s18, 4096
    buffer_load_dwordx4 a[48:51], v5, s[4:7], s18 offen offset:0
    buffer_load_dwordx4 a[52:55], v5, s[4:7], s18 offen offset:1024
    buffer_load_dwordx4 a[56:59], v5, s[4:7], s18 offen offset:2048
    buffer_load_dwordx4 a[60:63], v5, s[4:7], s18 offen offset:3072
    s_add_u32 s18, s18, 4096
    buffer_load_dwordx4 a[64:67], v5, s[4:7], s18 offen offset:0
    buffer_load_dwordx4 a[68:71], v5, s[4:7], s18 offen offset:1024
    buffer_load_dwordx4 a[72:75], v5, s[4:7], s18 offen offset:2048
    buffer_load_dwordx4 a[76:79], v5, s[4:7], s18 offen offset:3072
    s_add_u32 s18, s18, 4096
    buffer_load_dwordx4 a[80:83], v5, s[4:7], s18 offen offset:0
    buffer_load_dwordx4 a[84:87], v5, s[4:7], s18 offen offset:1024
    buffer_load_dwordx4 a[88:91], v5, s[4:7], s18 offen offset:2048
    buffer_load_dwordx4 a[92:95], v5, s[4:7], s18 offen offset:3072
    s_add_u32 s18, s18, 4096
    s_lshl_b32 s41, s36, 9
    s_add_u32 s41, s41, 0x440080
    s_cmp_lg_u32 s3, 0
    s_cbranch_scc1 L_wdone_32
    s_mov_b32 s42, 0x40000
    v_mov_b32 v255, 0
L_wloop_33:
    buffer_load_dword v254, v255, s[52:55], s41 offen sc0 sc1
    s_waitcnt vmcnt(0)
    v_readfirstlane_b32 s43, v254
    s_cmp_ge_u32 s43, 14
    s_cbranch_scc1 L_wdone_32
    s_sub_u32 s42, s42, 1
    s_cmp_eq_u32 s42, 0
    s_cbranch_scc1 L_wdone_32
    s_sleep 1
    s_branch L_wloop_33
L_wdone_32:
    s_barrier
    v_lshlrev_b32 v40, 14, v4
    v_lshl_add_u32 v40, v3, 3, v40
    v_add_u32 v41, 0x10000, v40
    v_cmp_gt_u32 vcc, 3, v4
    v_mov_b32 v248, 0x40000000
    s_lshl_b32 s30, s12, 7
    s_add_u32 s30, s30, 0x420000
    v_cndmask_b32 v41, v248, v41, vcc
    buffer_load_dwordx2 v[248:249], v40, s[52:55], s30 offen offset:0
    buffer_load_dwordx2 v[250:251], v41, s[52:55], s30 offen offset:0
    buffer_load_dwordx2 v[252:253], v40, s[52:55], s30 offen offset:128
    buffer_load_dwordx2 v[254:255], v41, s[52:55], s30 offen offset:128
    s_add_u32 s19, s16, 0
    s_mov_b32 m0, s19
    s_add_u32 s25, s14, 0
    buffer_load_dwordx4 v5, s[52:55], s25 offen lds
    s_add_u32 s19, s16, 1024
    s_mov_b32 m0, s19
    s_add_u32 s25, s15, 0
    buffer_load_dwordx4 v5, s[52:55], s25 offen lds
    s_add_u32 s19, s16, 8192
    s_mov_b32 m0, s19
    s_add_u32 s25, s14, 1024
    buffer_load_dwordx4 v5, s[52:55], s25 offen lds
    s_add_u32 s19, s16, 9216
    s_mov_b32 m0, s19
    s_add_u32 s25, s15, 1024
    buffer_load_dwordx4 v5, s[52:55], s25 offen lds
    s_add_u32 s19, s16, 16384
    s_mov_b32 m0, s19
    s_add_u32 s25, s14, 2048
    buffer_load_dwordx4 v5, s[52:55], s25 offen lds
    s_add_u32 s19, s16, 17408
    s_mov_b32 m0, s19
    s_add_u32 s25, s15, 2048
    buffer_load_dwordx4 v5, s[52:55], s25 offen lds
    s_add_u32 s19, s16, 24576
    s_mov_b32 m0, s19
    s_add_u32 s25, s14, 3072
    buffer_load_dwordx4 v5, s[52:55], s25 offen lds
    s_add_u32 s19, s16, 25600
    s_mov_b32 m0, s19
    s_add_u32 s25, s15, 3072
    buffer_load_dwordx4 v5, s[52:55], s25 offen lds
    s_add_u32 s19, s16, 32768
    s_mov_b32 m0, s19
    s_add_u32 s25, s14, 4096
    buffer_load_dwordx4 v5, s[52:55], s25 offen lds
    s_add_u32 s19, s16, 33792
    s_mov_b32 m0, s19
    s_add_u32 s25, s15, 4096
    buffer_load_dwordx4 v5, s[52:55], s25 offen lds
    s_add_u32 s19, s16, 40960
    s_mov_b32 m0, s19
    s_add_u32 s25, s14, 5120
    buffer_load_dwordx4 v5, s[52:55], s25 offen lds
    s_add_u32 s19, s16, 41984
    s_mov_b32 m0, s19
    s_add_u32 s25, s15, 5120
    buffer_load_dwordx4 v5, s[52:55], s25 offen lds
    s_waitcnt vmcnt(12)
    v_add_f32 v192, v248, v250
    v_add_f32 v194, v249, v251
    v_add_f32 v193, v252, v254
    v_add_f32 v195, v253, v255
    v_mov_b32 v42, v192
    v_mov_b32 v43, v193
    v_mov_b32 v44, v194
    v_mov_b32 v45, v195
    v_permlane16_swap_b32 v192, v42
    v_permlane16_swap_b32 v193, v43
    v_permlane16_swap_b32 v194, v44
    v_permlane16_swap_b32 v195, v45
    v_add_f32 v192, v192, v42
    v_add_f32 v193, v193, v43
    v_add_f32 v194, v194, v44
    v_add_f32 v195, v195, v45
    v_mov_b32 v42, v192
    v_mov_b32 v43, v193
    v_mov_b32 v44, v194
    v_mov_b32 v45, v195
    v_permlane32_swap_b32 v192, v42
    v_permlane32_swap_b32 v193, v43
    v_permlane32_swap_b32 v194, v44
    v_permlane32_swap_b32 v195, v45
    v_add_f32 v192, v192, v42
    v_add_f32 v193, v193, v43
    v_add_f32 v194, v194, v44
    v_add_f32 v195, v195, v45
    v_mul_f32 v192, s38, v192
    v_mul_f32 v194, s38, v194
    v_fma_f32 v194, -v192, v192, v194
    v_max_f32 v194, 0, v194
    v_cvt_pk_bf16_f32 v42, v192, v194
    v_lshlrev_b32 v192, 16, v42
    v_xor_b32 v192, 0x80000000, v192
    v_and_b32 v194, 0xffff0000, v42
    v_add_f32 v194, s39, v194
    v_cvt_pk_bf16_f32 v194, v194, v194
    v_and_b32 v194, 0xffff0000, v194
    v_sqrt_f32 v194, v194
    s_nop 0
    v_cvt_pk_bf16_f32 v194, v194, v194
    v_and_b32 v194, 0xffff0000, v194
    v_rcp_f32 v194, v194
    s_nop 0
    v_mul_f32 v193, s38, v193
    v_mul_f32 v195, s38, v195
    v_fma_f32 v195, -v193, v193, v195
    v_max_f32 v195, 0, v195
    v_cvt_pk_bf16_f32 v42, v193, v195
    v_lshlrev_b32 v193, 16, v42
    v_xor_b32 v193, 0x80000000, v193
    v_and_b32 v195, 0xffff0000, v42
    v_add_f32 v195, s39, v195
    v_cvt_pk_bf16_f32 v195, v195, v195
    v_and_b32 v195, 0xffff0000, v195
    v_sqrt_f32 v195, v195
    s_nop 0
    v_cvt_pk_bf16_f32 v195, v195, v195
    v_and_b32 v195, 0xffff0000, v195
    v_rcp_f32 v195, v195
    s_nop 0
    v_pk_add_f32 v[200:201], v[200:201], v[64:65]
    v_pk_add_f32 v[202:203], v[202:203], v[66:67]
    v_pk_add_f32 v[204:205], v[204:205], v[68:69]
    v_pk_add_f32 v[206:207], v[206:207], v[70:71]
    v_pk_add_f32 v[208:209], v[208:209], v[72:73]
    v_pk_add_f32 v[210:211], v[210:211], v[74:75]
    v_pk_add_f32 v[212:213], v[212:213], v[76:77]
    v_pk_add_f32 v[214:215], v[214:215], v[78:79]
    v_pk_add_f32 v[200:201], v[200:201], v[80:81]
    v_pk_add_f32 v[202:203], v[202:203], v[82:83]
    v_pk_add_f32 v[204:205], v[204:205], v[84:85]
    v_pk_add_f32 v[206:207], v[206:207], v[86:87]
    v_pk_add_f32 v[208:209], v[208:209], v[88:89]
    v_pk_add_f32 v[210:211], v[210:211], v[90:91]
    v_pk_add_f32 v[212:213], v[212:213], v[92:93]
    v_pk_add_f32 v[214:215], v[214:215], v[94:95]
    v_pk_add_f32 v[200:201], v[200:201], v[96:97]
    v_pk_add_f32 v[202:203], v[202:203], v[98:99]
    v_pk_add_f32 v[204:205], v[204:205], v[100:101]
    v_pk_add_f32 v[206:207], v[206:207], v[102:103]
    v_pk_add_f32 v[208:209], v[208:209], v[104:105]
    v_pk_add_f32 v[210:211], v[210:211], v[106:107]
    v_pk_add_f32 v[212:213], v[212:213], v[108:109]
    v_pk_add_f32 v[214:215], v[214:215], v[110:111]
    s_lshl_b32 s23, s3, 8
    s_add_u32 s23, s23, 114688
    v_lshlrev_b32 v6, 3, v3
    v_add_u32 v46, s23, v6
    v_mov_b32 v48, v192
    v_mov_b32 v49, v194
    v_mov_b32 v50, v193
    v_mov_b32 v51, v195
    ds_write_b64 v46, v[48:49]
    ds_write_b64 v46, v[50:51] offset:128
    s_waitcnt lgkmcnt(0)
    s_waitcnt vmcnt(10)
    s_barrier
    ds_read_b128 v[8:11], v5 offset:0
    ds_read_b128 v[12:15], v5 offset:1024
    ds_read_b128 v[16:19], v5 offset:2048
    ds_read_b128 v[20:23], v5 offset:3072
    ds_read_b128 v[24:27], v5 offset:4096
    ds_read_b128 v[28:31], v5 offset:5120
    ds_read_b128 v[32:35], v5 offset:6144
    ds_read_b128 v[36:39], v5 offset:7168
    s_add_u32 s19, s16, 49152
    s_mov_b32 m0, s19
    s_add_u32 s25, s14, 6144
    buffer_load_dwordx4 v5, s[52:55], s25 offen lds
    s_waitcnt lgkmcnt(7)
    v_mfma_f32_16x16x32_bf16 v[64:67], a[0:3], v[8:11], 0
    v_mfma_f32_16x16x32_bf16 v[68:71], a[4:7], v[8:11], 0
    s_add_u32 s19, s16, 50176
    s_mov_b32 m0, s19
    s_add_u32 s25, s15, 6144
    buffer_load_dwordx4 v5, s[52:55], s25 offen lds
    v_mfma_f32_16x16x32_bf16 v[72:75], a[8:11], v[8:11], 0
    v_mfma_f32_16x16x32_bf16 v[76:79], a[12:15], v[8:11], 0
    s_waitcnt lgkmcnt(6)
    v_mfma_f32_16x16x32_bf16 v[80:83], a[0:3], v[12:15], 0
    buffer_load_dwordx4 a[96:99], v5, s[4:7], s18 offen offset:0
    v_mfma_f32_16x16x32_bf16 v[84:87], a[4:7], v[12:15], 0
    v_mfma_f32_16x16x32_bf16 v[88:91], a[8:11], v[12:15], 0
    v_mfma_f32_16x16x32_bf16 v[92:95], a[12:15], v[12:15], 0
    buffer_load_dwordx4 a[100:103], v5, s[4:7], s18 offen offset:1024
    s_waitcnt lgkmcnt(5)
    v_mfma_f32_16x16x32_bf16 v[96:99], a[0:3], v[16:19], 0
    v_mfma_f32_16x16x32_bf16 v[100:103], a[4:7], v[16:19], 0
    buffer_load_dwordx4 a[104:107], v5, s[4:7], s18 offen offset:2048
    v_mfma_f32_16x16x32_bf16 v[104:107], a[8:11], v[16:19], 0
    v_mfma_f32_16x16x32_bf16 v[108:111], a[12:15], v[16:19], 0
    s_waitcnt lgkmcnt(4)
    v_mfma_f32_16x16x32_bf16 v[112:115], a[0:3], v[20:23], 0
    buffer_load_dwordx4 a[108:111], v5, s[4:7], s18 offen offset:3072
    s_add_u32 s18, s18, 4096
    v_mfma_f32_16x16x32_bf16 v[116:119], a[4:7], v[20:23], 0
    v_mfma_f32_16x16x32_bf16 v[120:123], a[8:11], v[20:23], 0
    v_mfma_f32_16x16x32_bf16 v[124:127], a[12:15], v[20:23], 0
    s_waitcnt vmcnt(14)
    s_barrier
    ds_read_b128 v[216:219], v5 offset:8192
    s_waitcnt lgkmcnt(4)
    v_mfma_f32_16x16x32_bf16 v[128:131], a[0:3], v[24:27], 0
    v_mfma_f32_16x16x32_bf16 v[132:135], a[4:7], v[24:27], 0
    ds_read_b128 v[220:223], v5 offset:9216
    v_mfma_f32_16x16x32_bf16 v[136:139], a[8:11], v[24:27], 0
    v_mfma_f32_16x16x32_bf16 v[140:143], a[12:15], v[24:27], 0
    ds_read_b128 v[224:227], v5 offset:10240
    s_waitcnt lgkmcnt(5)
    v_mfma_f32_16x16x32_bf16 v[144:147], a[0:3], v[28:31], 0
    v_mfma_f32_16x16x32_bf16 v[148:151], a[4:7], v[28:31], 0
    ds_read_b128 v[228:231], v5 offset:11264
    v_mfma_f32_16x16x32_bf16 v[152:155], a[8:11], v[28:31], 0
    v_mfma_f32_16x16x32_bf16 v[156:159], a[12:15], v[28:31], 0
    ds_read_b128 v[232:235], v5 offset:12288
    s_waitcnt lgkmcnt(6)
    v_mfma_f32_16x16x32_bf16 v[160:163], a[0:3], v[32:35], 0
    v_mfma_f32_16x16x32_bf16 v[164:167], a[4:7], v[32:35], 0
    ds_read_b128 v[236:239], v5 offset:13312
    v_mfma_f32_16x16x32_bf16 v[168:171], a[8:11], v[32:35], 0
    v_mfma_f32_16x16x32_bf16 v[172:175], a[12:15], v[32:35], 0
    ds_read_b128 v[240:243], v5 offset:14336
    s_waitcnt lgkmcnt(7)
    v_mfma_f32_16x16x32_bf16 v[176:179], a[0:3], v[36:39], 0
    v_mfma_f32_16x16x32_bf16 v[180:183], a[4:7], v[36:39], 0
    ds_read_b128 v[244:247], v5 offset:15360
    v_mfma_f32_16x16x32_bf16 v[184:187], a[8:11], v[36:39], 0
    v_mfma_f32_16x16x32_bf16 v[188:191], a[12:15], v[36:39], 0
    s_add_u32 s19, s16, 57344
    s_mov_b32 m0, s19
    s_add_u32 s25, s14, 7168
    buffer_load_dwordx4 v5, s[52:55], s25 offen lds
    s_waitcnt lgkmcnt(7)
    v_mfma_f32_16x16x32_bf16 v[64:67], a[16:19], v[216:219], v[64:67]
    v_mfma_f32_16x16x32_bf16 v[68:71], a[20:23], v[216:219], v[68:71]
    s_add_u32 s19, s16, 58368
    s_mov_b32 m0, s19
    s_add_u32 s25, s15, 7168
    buffer_load_dwordx4 v5, s[52:55], s25 offen lds
    v_mfma_f32_16x16x32_bf16 v[72:75], a[24:27], v[216:219], v[72:75]
    v_mfma_f32_16x16x32_bf16 v[76:79], a[28:31], v[216:219], v[76:79]
    s_waitcnt lgkmcnt(6)
    v_mfma_f32_16x16x32_bf16 v[80:83], a[16:19], v[220:223], v[80:83]
    buffer_load_dwordx4 a[112:115], v5, s[4:7], s18 offen offset:0
    v_mfma_f32_16x16x32_bf16 v[84:87], a[20:23], v[220:223], v[84:87]
    v_mfma_f32_16x16x32_bf16 v[88:91], a[24:27], v[220:223], v[88:91]
    v_mfma_f32_16x16x32_bf16 v[92:95], a[28:31], v[220:223], v[92:95]
    buffer_load_dwordx4 a[116:119], v5, s[4:7], s18 offen offset:1024
    s_waitcnt lgkmcnt(5)
    v_mfma_f32_16x16x32_bf16 v[96:99], a[16:19], v[224:227], v[96:99]
    v_mfma_f32_16x16x32_bf16 v[100:103], a[20:23], v[224:227], v[100:103]
    buffer_load_dwordx4 a[120:123], v5, s[4:7], s18 offen offset:2048
    v_mfma_f32_16x16x32_bf16 v[104:107], a[24:27], v[224:227], v[104:107]
    v_mfma_f32_16x16x32_bf16 v[108:111], a[28:31], v[224:227], v[108:111]
    s_waitcnt lgkmcnt(4)
    v_mfma_f32_16x16x32_bf16 v[112:115], a[16:19], v[228:231], v[112:115]
    buffer_load_dwordx4 a[124:127], v5, s[4:7], s18 offen offset:3072
    s_add_u32 s18, s18, 4096
    v_mfma_f32_16x16x32_bf16 v[116:119], a[20:23], v[228:231], v[116:119]
    v_mfma_f32_16x16x32_bf16 v[120:123], a[24:27], v[228:231], v[120:123]
    v_mfma_f32_16x16x32_bf16 v[124:127], a[28:31], v[228:231], v[124:127]
    s_waitcnt vmcnt(18)
    s_barrier
    ds_read_b128 v[8:11], v5 offset:16384
    s_waitcnt lgkmcnt(4)
    v_mfma_f32_16x16x32_bf16 v[128:131], a[16:19], v[232:235], v[128:131]
    v_mfma_f32_16x16x32_bf16 v[132:135], a[20:23], v[232:235], v[132:135]
    ds_read_b128 v[12:15], v5 offset:17408
    v_mfma_f32_16x16x32_bf16 v[136:139], a[24:27], v[232:235], v[136:139]
    v_mfma_f32_16x16x32_bf16 v[140:143], a[28:31], v[232:235], v[140:143]
    ds_read_b128 v[16:19], v5 offset:18432
    s_waitcnt lgkmcnt(5)
    v_mfma_f32_16x16x32_bf16 v[144:147], a[16:19], v[236:239], v[144:147]
    v_mfma_f32_16x16x32_bf16 v[148:151], a[20:23], v[236:239], v[148:151]
    ds_read_b128 v[20:23], v5 offset:19456
    v_mfma_f32_16x16x32_bf16 v[152:155], a[24:27], v[236:239], v[152:155]
    v_mfma_f32_16x16x32_bf16 v[156:159], a[28:31], v[236:239], v[156:159]
    ds_read_b128 v[24:27], v5 offset:20480
    s_waitcnt lgkmcnt(6)
    v_mfma_f32_16x16x32_bf16 v[160:163], a[16:19], v[240:243], v[160:163]
    v_mfma_f32_16x16x32_bf16 v[164:167], a[20:23], v[240:243], v[164:167]
    ds_read_b128 v[28:31], v5 offset:21504
    v_mfma_f32_16x16x32_bf16 v[168:171], a[24:27], v[240:243], v[168:171]
    v_mfma_f32_16x16x32_bf16 v[172:175], a[28:31], v[240:243], v[172:175]
    ds_read_b128 v[32:35], v5 offset:22528
    s_waitcnt lgkmcnt(7)
    v_mfma_f32_16x16x32_bf16 v[176:179], a[16:19], v[244:247], v[176:179]
    v_mfma_f32_16x16x32_bf16 v[180:183], a[20:23], v[244:247], v[180:183]
    ds_read_b128 v[36:39], v5 offset:23552
    v_mfma_f32_16x16x32_bf16 v[184:187], a[24:27], v[244:247], v[184:187]
    v_mfma_f32_16x16x32_bf16 v[188:191], a[28:31], v[244:247], v[188:191]
    s_add_u32 s19, s16, 65536
    s_mov_b32 m0, s19
    s_add_u32 s25, s14, 8192
    buffer_load_dwordx4 v5, s[52:55], s25 offen lds
    s_waitcnt lgkmcnt(7)
    v_mfma_f32_16x16x32_bf16 v[64:67], a[32:35], v[8:11], v[64:67]
    v_mfma_f32_16x16x32_bf16 v[68:71], a[36:39], v[8:11], v[68:71]
    s_add_u32 s19, s16, 66560
    s_mov_b32 m0, s19
    s_add_u32 s25, s15, 8192
    buffer_load_dwordx4 v5, s[52:55], s25 offen lds
    v_mfma_f32_16x16x32_bf16 v[72:75], a[40:43], v[8:11], v[72:75]
    v_mfma_f32_16x16x32_bf16 v[76:79], a[44:47], v[8:11], v[76:79]
    s_waitcnt lgkmcnt(6)
    v_mfma_f32_16x16x32_bf16 v[80:83], a[32:35], v[12:15], v[80:83]
    buffer_load_dwordx4 a[128:131], v5, s[4:7], s18 offen offset:0
    v_mfma_f32_16x16x32_bf16 v[84:87], a[36:39], v[12:15], v[84:87]
    v_mfma_f32_16x16x32_bf16 v[88:91], a[40:43], v[12:15], v[88:91]
    v_mfma_f32_16x16x32_bf16 v[92:95], a[44:47], v[12:15], v[92:95]
    buffer_load_dwordx4 a[132:135], v5, s[4:7], s18 offen offset:1024
    s_waitcnt lgkmcnt(5)
    v_mfma_f32_16x16x32_bf16 v[96:99], a[32:35], v[16:19], v[96:99]
    v_mfma_f32_16x16x32_bf16 v[100:103], a[36:39], v[16:19], v[100:103]
    buffer_load_dwordx4 a[136:139], v5, s[4:7], s18 offen offset:2048
    v_mfma_f32_16x16x32_bf16 v[104:107], a[40:43], v[16:19], v[104:107]
    v_mfma_f32_16x16x32_bf16 v[108:111], a[44:47], v[16:19], v[108:111]
    s_waitcnt lgkmcnt(4)
    v_mfma_f32_16x16x32_bf16 v[112:115], a[32:35], v[20:23], v[112:115]
    buffer_load_dwordx4 a[140:143], v5, s[4:7], s18 offen offset:3072
    s_add_u32 s18, s18, 4096
    v_mfma_f32_16x16x32_bf16 v[116:119], a[36:39], v[20:23], v[116:119]
    v_mfma_f32_16x16x32_bf16 v[120:123], a[40:43], v[20:23], v[120:123]
    v_mfma_f32_16x16x32_bf16 v[124:127], a[44:47], v[20:23], v[124:127]
    s_waitcnt vmcnt(22)
    s_barrier
    ds_read_b128 v[216:219], v5 offset:24576
    s_waitcnt lgkmcnt(4)
    v_mfma_f32_16x16x32_bf16 v[128:131], a[32:35], v[24:27], v[128:131]
    v_mfma_f32_16x16x32_bf16 v[132:135], a[36:39], v[24:27], v[132:135]
    ds_read_b128 v[220:223], v5 offset:25600
    v_mfma_f32_16x16x32_bf16 v[136:139], a[40:43], v[24:27], v[136:139]
    v_mfma_f32_16x16x32_bf16 v[140:143], a[44:47], v[24:27], v[140:143]
    ds_read_b128 v[224:227], v5 offset:26624
    s_waitcnt lgkmcnt(5)
    v_mfma_f32_16x16x32_bf16 v[144:147], a[32:35], v[28:31], v[144:147]
    v_mfma_f32_16x16x32_bf16 v[148:151], a[36:39], v[28:31], v[148:151]
    ds_read_b128 v[228:231], v5 offset:27648
    v_mfma_f32_16x16x32_bf16 v[152:155], a[40:43], v[28:31], v[152:155]
    v_mfma_f32_16x16x32_bf16 v[156:159], a[44:47], v[28:31], v[156:159]
    ds_read_b128 v[232:235], v5 offset:28672
    s_waitcnt lgkmcnt(6)
    v_mfma_f32_16x16x32_bf16 v[160:163], a[32:35], v[32:35], v[160:163]
    v_mfma_f32_16x16x32_bf16 v[164:167], a[36:39], v[32:35], v[164:167]
    ds_read_b128 v[236:239], v5 offset:29696
    v_mfma_f32_16x16x32_bf16 v[168:171], a[40:43], v[32:35], v[168:171]
    v_mfma_f32_16x16x32_bf16 v[172:175], a[44:47], v[32:35], v[172:175]
    ds_read_b128 v[240:243], v5 offset:30720
    s_waitcnt lgkmcnt(7)
    v_mfma_f32_16x16x32_bf16 v[176:179], a[32:35], v[36:39], v[176:179]
    v_mfma_f32_16x16x32_bf16 v[180:183], a[36:39], v[36:39], v[180:183]
    ds_read_b128 v[244:247], v5 offset:31744
    v_mfma_f32_16x16x32_bf16 v[184:187], a[40:43], v[36:39], v[184:187]
    v_mfma_f32_16x16x32_bf16 v[188:191], a[44:47], v[36:39], v[188:191]
    s_add_u32 s19, s16, 73728
    s_mov_b32 m0, s19
    s_add_u32 s25, s14, 9216
    buffer_load_dwordx4 v5, s[52:55], s25 offen lds
    s_waitcnt lgkmcnt(7)
    v_mfma_f32_16x16x32_bf16 v[64:67], a[48:51], v[216:219], v[64:67]
    v_mfma_f32_16x16x32_bf16 v[68:71], a[52:55], v[216:219], v[68:71]
    s_add_u32 s19, s16, 74752
    s_mov_b32 m0, s19
    s_add_u32 s25, s15, 9216
    buffer_load_dwordx4 v5, s[52:55], s25 offen lds
    v_mfma_f32_16x16x32_bf16 v[72:75], a[56:59], v[216:219], v[72:75]
    v_mfma_f32_16x16x32_bf16 v[76:79], a[60:63], v[216:219], v[76:79]
    s_waitcnt lgkmcnt(6)
    v_mfma_f32_16x16x32_bf16 v[80:83], a[48:51], v[220:223], v[80:83]
    buffer_load_dwordx4 a[144:147], v5, s[4:7], s18 offen offset:0
    v_mfma_f32_16x16x32_bf16 v[84:87], a[52:55], v[220:223], v[84:87]
    v_mfma_f32_16x16x32_bf16 v[88:91], a[56:59], v[220:223], v[88:91]
    v_mfma_f32_16x16x32_bf16 v[92:95], a[60:63], v[220:223], v[92:95]
    buffer_load_dwordx4 a[148:151], v5, s[4:7], s18 offen offset:1024
    s_waitcnt lgkmcnt(5)
    v_mfma_f32_16x16x32_bf16 v[96:99], a[48:51], v[224:227], v[96:99]
    v_mfma_f32_16x16x32_bf16 v[100:103], a[52:55], v[224:227], v[100:103]
    buffer_load_dwordx4 a[152:155], v5, s[4:7], s18 offen offset:2048
    v_mfma_f32_16x16x32_bf16 v[104:107], a[56:59], v[224:227], v[104:107]
    v_mfma_f32_16x16x32_bf16 v[108:111], a[60:63], v[224:227], v[108:111]
    s_waitcnt lgkmcnt(4)
    v_mfma_f32_16x16x32_bf16 v[112:115], a[48:51], v[228:231], v[112:115]
    buffer_load_dwordx4 a[156:159], v5, s[4:7], s18 offen offset:3072
    s_add_u32 s18, s18, 4096
    v_mfma_f32_16x16x32_bf16 v[116:119], a[52:55], v[228:231], v[116:119]
    v_mfma_f32_16x16x32_bf16 v[120:123], a[56:59], v[228:231], v[120:123]
    v_mfma_f32_16x16x32_bf16 v[124:127], a[60:63], v[228:231], v[124:127]
    s_waitcnt vmcnt(26)
    s_barrier
    ds_read_b128 v[8:11], v5 offset:32768
    s_waitcnt lgkmcnt(4)
    v_mfma_f32_16x16x32_bf16 v[128:131], a[48:51], v[232:235], v[128:131]
    v_mfma_f32_16x16x32_bf16 v[132:135], a[52:55], v[232:235], v[132:135]
    ds_read_b128 v[12:15], v5 offset:33792
    v_mfma_f32_16x16x32_bf16 v[136:139], a[56:59], v[232:235], v[136:139]
    v_mfma_f32_16x16x32_bf16 v[140:143], a[60:63], v[232:235], v[140:143]
    ds_read_b128 v[16:19], v5 offset:34816
    s_waitcnt lgkmcnt(5)
    v_mfma_f32_16x16x32_bf16 v[144:147], a[48:51], v[236:239], v[144:147]
    v_mfma_f32_16x16x32_bf16 v[148:151], a[52:55], v[236:239], v[148:151]
    ds_read_b128 v[20:23], v5 offset:35840
    v_mfma_f32_16x16x32_bf16 v[152:155], a[56:59], v[236:239], v[152:155]
    v_mfma_f32_16x16x32_bf16 v[156:159], a[60:63], v[236:239], v[156:159]
    ds_read_b128 v[24:27], v5 offset:36864
    s_waitcnt lgkmcnt(6)
    v_mfma_f32_16x16x32_bf16 v[160:163], a[48:51], v[240:243], v[160:163]
    v_mfma_f32_16x16x32_bf16 v[164:167], a[52:55], v[240:243], v[164:167]
    ds_read_b128 v[28:31], v5 offset:37888
    v_mfma_f32_16x16x32_bf16 v[168:171], a[56:59], v[240:243], v[168:171]
    v_mfma_f32_16x16x32_bf16 v[172:175], a[60:63], v[240:243], v[172:175]
    ds_read_b128 v[32:35], v5 offset:38912
    s_waitcnt lgkmcnt(7)
    v_mfma_f32_16x16x32_bf16 v[176:179], a[48:51], v[244:247], v[176:179]
    v_mfma_f32_16x16x32_bf16 v[180:183], a[52:55], v[244:247], v[180:183]
    ds_read_b128 v[36:39], v5 offset:39936
    v_mfma_f32_16x16x32_bf16 v[184:187], a[56:59], v[244:247], v[184:187]
    v_mfma_f32_16x16x32_bf16 v[188:191], a[60:63], v[244:247], v[188:191]
    s_add_u32 s19, s16, 81920
    s_mov_b32 m0, s19
    s_add_u32 s25, s14, 10240
    buffer_load_dwordx4 v5, s[52:55], s25 offen lds
    s_waitcnt lgkmcnt(7)
    v_mfma_f32_16x16x32_bf16 v[64:67], a[64:67], v[8:11], v[64:67]
    v_mfma_f32_16x16x32_bf16 v[68:71], a[68:71], v[8:11], v[68:71]
    s_add_u32 s19, s16, 82944
    s_mov_b32 m0, s19
    s_add_u32 s25, s15, 10240
    buffer_load_dwordx4 v5, s[52:55], s25 offen lds
    v_mfma_f32_16x16x32_bf16 v[72:75], a[72:75], v[8:11], v[72:75]
    v_mfma_f32_16x16x32_bf16 v[76:79], a[76:79], v[8:11], v[76:79]
    s_waitcnt lgkmcnt(6)
    v_mfma_f32_16x16x32_bf16 v[80:83], a[64:67], v[12:15], v[80:83]
    buffer_load_dwordx4 a[160:163], v5, s[4:7], s18 offen offset:0
    v_mfma_f32_16x16x32_bf16 v[84:87], a[68:71], v[12:15], v[84:87]
    v_mfma_f32_16x16x32_bf16 v[88:91], a[72:75], v[12:15], v[88:91]
    v_mfma_f32_16x16x32_bf16 v[92:95], a[76:79], v[12:15], v[92:95]
    buffer_load_dwordx4 a[164:167], v5, s[4:7], s18 offen offset:1024
    s_waitcnt lgkmcnt(5)
    v_mfma_f32_16x16x32_bf16 v[96:99], a[64:67], v[16:19], v[96:99]
    v_mfma_f32_16x16x32_bf16 v[100:103], a[68:71], v[16:19], v[100:103]
    buffer_load_dwordx4 a[168:171], v5, s[4:7], s18 offen offset:2048
    v_mfma_f32_16x16x32_bf16 v[104:107], a[72:75], v[16:19], v[104:107]
    v_mfma_f32_16x16x32_bf16 v[108:111], a[76:79], v[16:19], v[108:111]
    s_waitcnt lgkmcnt(4)
    v_mfma_f32_16x16x32_bf16 v[112:115], a[64:67], v[20:23], v[112:115]
    buffer_load_dwordx4 a[172:175], v5, s[4:7], s18 offen offset:3072
    s_add_u32 s18, s18, 4096
    v_mfma_f32_16x16x32_bf16 v[116:119], a[68:71], v[20:23], v[116:119]
    v_mfma_f32_16x16x32_bf16 v[120:123], a[72:75], v[20:23], v[120:123]
    v_mfma_f32_16x16x32_bf16 v[124:127], a[76:79], v[20:23], v[124:127]
    s_waitcnt vmcnt(30)
    s_barrier
    ds_read_b128 v[216:219], v5 offset:40960
    s_waitcnt lgkmcnt(4)
    v_mfma_f32_16x16x32_bf16 v[128:131], a[64:67], v[24:27], v[128:131]
    v_mfma_f32_16x16x32_bf16 v[132:135], a[68:71], v[24:27], v[132:135]
    ds_read_b128 v[220:223], v5 offset:41984
    v_mfma_f32_16x16x32_bf16 v[136:139], a[72:75], v[24:27], v[136:139]
    v_mfma_f32_16x16x32_bf16 v[140:143], a[76:79], v[24:27], v[140:143]
    ds_read_b128 v[224:227], v5 offset:43008
    s_waitcnt lgkmcnt(5)
    v_mfma_f32_16x16x32_bf16 v[144:147], a[64:67], v[28:31], v[144:147]
    v_mfma_f32_16x16x32_bf16 v[148:151], a[68:71], v[28:31], v[148:151]
    ds_read_b128 v[228:231], v5 offset:44032
    v_mfma_f32_16x16x32_bf16 v[152:155], a[72:75], v[28:31], v[152:155]
    v_mfma_f32_16x16x32_bf16 v[156:159], a[76:79], v[28:31], v[156:159]
    ds_read_b128 v[232:235], v5 offset:45056
    s_waitcnt lgkmcnt(6)
    v_mfma_f32_16x16x32_bf16 v[160:163], a[64:67], v[32:35], v[160:163]
    v_mfma_f32_16x16x32_bf16 v[164:167], a[68:71], v[32:35], v[164:167]
    ds_read_b128 v[236:239], v5 offset:46080
    v_mfma_f32_16x16x32_bf16 v[168:171], a[72:75], v[32:35], v[168:171]
    v_mfma_f32_16x16x32_bf16 v[172:175], a[76:79], v[32:35], v[172:175]
    ds_read_b128 v[240:243], v5 offset:47104
    s_waitcnt lgkmcnt(7)
    v_mfma_f32_16x16x32_bf16 v[176:179], a[64:67], v[36:39], v[176:179]
    v_mfma_f32_16x16x32_bf16 v[180:183], a[68:71], v[36:39], v[180:183]
    ds_read_b128 v[244:247], v5 offset:48128
    v_mfma_f32_16x16x32_bf16 v[184:187], a[72:75], v[36:39], v[184:187]
    v_mfma_f32_16x16x32_bf16 v[188:191], a[76:79], v[36:39], v[188:191]
    s_add_u32 s19, s16, 90112
    s_mov_b32 m0, s19
    s_add_u32 s25, s14, 11264
    buffer_load_dwordx4 v5, s[52:55], s25 offen lds
    s_waitcnt lgkmcnt(7)
    v_mfma_f32_16x16x32_bf16 v[64:67], a[80:83], v[216:219], v[64:67]
    v_mfma_f32_16x16x32_bf16 v[68:71], a[84:87], v[216:219], v[68:71]
    s_add_u32 s19, s16, 91136
    s_mov_b32 m0, s19
    s_add_u32 s25, s15, 11264
    buffer_load_dwordx4 v5, s[52:55], s25 offen lds
    v_mfma_f32_16x16x32_bf16 v[72:75], a[88:91], v[216:219], v[72:75]
    v_mfma_f32_16x16x32_bf16 v[76:79], a[92:95], v[216:219], v[76:79]
    s_waitcnt lgkmcnt(6)
    v_mfma_f32_16x16x32_bf16 v[80:83], a[80:83], v[220:223], v[80:83]
    buffer_load_dwordx4 a[176:179], v5, s[4:7], s18 offen offset:0
    v_mfma_f32_16x16x32_bf16 v[84:87], a[84:87], v[220:223], v[84:87]
    v_mfma_f32_16x16x32_bf16 v[88:91], a[88:91], v[220:223], v[88:91]
    v_mfma_f32_16x16x32_bf16 v[92:95], a[92:95], v[220:223], v[92:95]
    buffer_load_dwordx4 a[180:183], v5, s[4:7], s18 offen offset:1024
    s_waitcnt lgkmcnt(5)
    v_mfma_f32_16x16x32_bf16 v[96:99], a[80:83], v[224:227], v[96:99]
    v_mfma_f32_16x16x32_bf16 v[100:103], a[84:87], v[224:227], v[100:103]
    buffer_load_dwordx4 a[184:187], v5, s[4:7], s18 offen offset:2048
    v_mfma_f32_16x16x32_bf16 v[104:107], a[88:91], v[224:227], v[104:107]
    v_mfma_f32_16x16x32_bf16 v[108:111], a[92:95], v[224:227], v[108:111]
    s_waitcnt lgkmcnt(4)
    v_mfma_f32_16x16x32_bf16 v[112:115], a[80:83], v[228:231], v[112:115]
    buffer_load_dwordx4 a[188:191], v5, s[4:7], s18 offen offset:3072
    s_add_u32 s18, s18, 4096
    v_mfma_f32_16x16x32_bf16 v[116:119], a[84:87], v[228:231], v[116:119]
    v_mfma_f32_16x16x32_bf16 v[120:123], a[88:91], v[228:231], v[120:123]
    v_mfma_f32_16x16x32_bf16 v[124:127], a[92:95], v[228:231], v[124:127]
    s_waitcnt vmcnt(30)
    s_barrier
    ds_read_b128 v[8:11], v5 offset:49152
    s_waitcnt lgkmcnt(4)
    v_mfma_f32_16x16x32_bf16 v[128:131], a[80:83], v[232:235], v[128:131]
    v_mfma_f32_16x16x32_bf16 v[132:135], a[84:87], v[232:235], v[132:135]
    ds_read_b128 v[12:15], v5 offset:50176
    v_mfma_f32_16x16x32_bf16 v[136:139], a[88:91], v[232:235], v[136:139]
    v_mfma_f32_16x16x32_bf16 v[140:143], a[92:95], v[232:235], v[140:143]
    ds_read_b128 v[16:19], v5 offset:51200
    s_waitcnt lgkmcnt(5)
    v_mfma_f32_16x16x32_bf16 v[144:147], a[80:83], v[236:239], v[144:147]
    v_mfma_f32_16x16x32_bf16 v[148:151], a[84:87], v[236:239], v[148:151]
    ds_read_b128 v[20:23], v5 offset:52224
    v_mfma_f32_16x16x32_bf16 v[152:155], a[88:91], v[236:239], v[152:155]
    v_mfma_f32_16x16x32_bf16 v[156:159], a[92:95], v[236:239], v[156:159]
    ds_read_b128 v[24:27], v5 offset:53248
    s_waitcnt lgkmcnt(6)
    v_mfma_f32_16x16x32_bf16 v[160:163], a[80:83], v[240:243], v[160:163]
    v_mfma_f32_16x16x32_bf16 v[164:167], a[84:87], v[240:243], v[164:167]
    ds_read_b128 v[28:31], v5 offset:54272
    v_mfma_f32_16x16x32_bf16 v[168:171], a[88:91], v[240:243], v[168:171]
    v_mfma_f32_16x16x32_bf16 v[172:175], a[92:95], v[240:243], v[172:175]
    ds_read_b128 v[32:35], v5 offset:55296
    s_waitcnt lgkmcnt(7)
    v_mfma_f32_16x16x32_bf16 v[176:179], a[80:83], v[244:247], v[176:179]
    v_mfma_f32_16x16x32_bf16 v[180:183], a[84:87], v[244:247], v[180:183]
    ds_read_b128 v[36:39], v5 offset:56320
    v_mfma_f32_16x16x32_bf16 v[184:187], a[88:91], v[244:247], v[184:187]
    v_mfma_f32_16x16x32_bf16 v[188:191], a[92:95], v[244:247], v[188:191]
    s_add_u32 s19, s16, 98304
    s_mov_b32 m0, s19
    s_add_u32 s25, s14, 12288
    buffer_load_dwordx4 v5, s[52:55], s25 offen lds
    s_waitcnt lgkmcnt(7)
    v_mfma_f32_16x16x32_bf16 v[64:67], a[96:99], v[8:11], v[64:67]
    v_mfma_f32_16x16x32_bf16 v[68:71], a[100:103], v[8:11], v[68:71]
    s_add_u32 s19, s16, 99328
    s_mov_b32 m0, s19
    s_add_u32 s25, s15, 12288
    buffer_load_dwordx4 v5, s[52:55], s25 offen lds
    v_mfma_f32_16x16x32_bf16 v[72:75], a[104:107], v[8:11], v[72:75]
    v_mfma_f32_16x16x32_bf16 v[76:79], a[108:111], v[8:11], v[76:79]
    s_waitcnt lgkmcnt(6)
    v_mfma_f32_16x16x32_bf16 v[80:83], a[96:99], v[12:15], v[80:83]
    buffer_load_dwordx4 a[192:195], v5, s[4:7], s18 offen offset:0
    v_mfma_f32_16x16x32_bf16 v[84:87], a[100:103], v[12:15], v[84:87]
    v_mfma_f32_16x16x32_bf16 v[88:91], a[104:107], v[12:15], v[88:91]
    v_mfma_f32_16x16x32_bf16 v[92:95], a[108:111], v[12:15], v[92:95]
    buffer_load_dwordx4 a[196:199], v5, s[4:7], s18 offen offset:1024
    s_waitcnt lgkmcnt(5)
    v_mfma_f32_16x16x32_bf16 v[96:99], a[96:99], v[16:19], v[96:99]
    v_mfma_f32_16x16x32_bf16 v[100:103], a[100:103], v[16:19], v[100:103]
    buffer_load_dwordx4 a[200:203], v5, s[4:7], s18 offen offset:2048
    v_mfma_f32_16x16x32_bf16 v[104:107], a[104:107], v[16:19], v[104:107]
    v_mfma_f32_16x16x32_bf16 v[108:111], a[108:111], v[16:19], v[108:111]
    s_waitcnt lgkmcnt(4)
    v_mfma_f32_16x16x32_bf16 v[112:115], a[96:99], v[20:23], v[112:115]
    buffer_load_dwordx4 a[204:207], v5, s[4:7], s18 offen offset:3072
    s_add_u32 s18, s18, 4096
    v_mfma_f32_16x16x32_bf16 v[116:119], a[100:103], v[20:23], v[116:119]
    v_mfma_f32_16x16x32_bf16 v[120:123], a[104:107], v[20:23], v[120:123]
    v_mfma_f32_16x16x32_bf16 v[124:127], a[108:111], v[20:23], v[124:127]
    s_waitcnt vmcnt(30)
    s_barrier
    ds_read_b128 v[216:219], v5 offset:57344
    s_waitcnt lgkmcnt(4)
    v_mfma_f32_16x16x32_bf16 v[128:131], a[96:99], v[24:27], v[128:131]
    v_mfma_f32_16x16x32_bf16 v[132:135], a[100:103], v[24:27], v[132:135]
    ds_read_b128 v[220:223], v5 offset:58368
    v_mfma_f32_16x16x32_bf16 v[136:139], a[104:107], v[24:27], v[136:139]
    v_mfma_f32_16x16x32_bf16 v[140:143], a[108:111], v[24:27], v[140:143]
    ds_read_b128 v[224:227], v5 offset:59392
    s_waitcnt lgkmcnt(5)
    v_mfma_f32_16x16x32_bf16 v[144:147], a[96:99], v[28:31], v[144:147]
    v_mfma_f32_16x16x32_bf16 v[148:151], a[100:103], v[28:31], v[148:151]
    ds_read_b128 v[228:231], v5 offset:60416
    v_mfma_f32_16x16x32_bf16 v[152:155], a[104:107], v[28:31], v[152:155]
    v_mfma_f32_16x16x32_bf16 v[156:159], a[108:111], v[28:31], v[156:159]
    ds_read_b128 v[232:235], v5 offset:61440
    s_waitcnt lgkmcnt(6)
    v_mfma_f32_16x16x32_bf16 v[160:163], a[96:99], v[32:35], v[160:163]
    v_mfma_f32_16x16x32_bf16 v[164:167], a[100:103], v[32:35], v[164:167]
    ds_read_b128 v[236:239], v5 offset:62464
    v_mfma_f32_16x16x32_bf16 v[168:171], a[104:107], v[32:35], v[168:171]
    v_mfma_f32_16x16x32_bf16 v[172:175], a[108:111], v[32:35], v[172:175]
    ds_read_b128 v[240:243], v5 offset:63488
    s_waitcnt lgkmcnt(7)
    v_mfma_f32_16x16x32_bf16 v[176:179], a[96:99], v[36:39], v[176:179]
    v_mfma_f32_16x16x32_bf16 v[180:183], a[100:103], v[36:39], v[180:183]
    ds_read_b128 v[244:247], v5 offset:64512
    v_mfma_f32_16x16x32_bf16 v[184:187], a[104:107], v[36:39], v[184:187]
    v_mfma_f32_16x16x32_bf16 v[188:191], a[108:111], v[36:39], v[188:191]
    s_add_u32 s19, s16, 106496
    s_mov_b32 m0, s19
    s_add_u32 s25, s14, 13312
    buffer_load_dwordx4 v5, s[52:55], s25 offen lds
    s_waitcnt lgkmcnt(7)
    v_mfma_f32_16x16x32_bf16 v[64:67], a[112:115], v[216:219], v[64:67]
    v_mfma_f32_16x16x32_bf16 v[68:71], a[116:119], v[216:219], v[68:71]
    s_add_u32 s19, s16, 107520
    s_mov_b32 m0, s19
    s_add_u32 s25, s15, 13312
    buffer_load_dwordx4 v5, s[52:55], s25 offen lds
    v_mfma_f32_16x16x32_bf16 v[72:75], a[120:123], v[216:219], v[72:75]
    v_mfma_f32_16x16x32_bf16 v[76:79], a[124:127], v[216:219], v[76:79]
    s_waitcnt lgkmcnt(6)
    v_mfma_f32_16x16x32_bf16 v[80:83], a[112:115], v[220:223], v[80:83]
    buffer_load_dwordx4 a[208:211], v5, s[4:7], s18 offen offset:0
    v_mfma_f32_16x16x32_bf16 v[84:87], a[116:119], v[220:223], v[84:87]
    v_mfma_f32_16x16x32_bf16 v[88:91], a[120:123], v[220:223], v[88:91]
    v_mfma_f32_16x16x32_bf16 v[92:95], a[124:127], v[220:223], v[92:95]
    buffer_load_dwordx4 a[212:215], v5, s[4:7], s18 offen offset:1024
    s_waitcnt lgkmcnt(5)
    v_mfma_f32_16x16x32_bf16 v[96:99], a[112:115], v[224:227], v[96:99]
    v_mfma_f32_16x16x32_bf16 v[100:103], a[116:119], v[224:227], v[100:103]
    buffer_load_dwordx4 a[216:219], v5, s[4:7], s18 offen offset:2048
    v_mfma_f32_16x16x32_bf16 v[104:107], a[120:123], v[224:227], v[104:107]
    v_mfma_f32_16x16x32_bf16 v[108:111], a[124:127], v[224:227], v[108:111]
    s_waitcnt lgkmcnt(4)
    v_mfma_f32_16x16x32_bf16 v[112:115], a[112:115], v[228:231], v[112:115]
    buffer_load_dwordx4 a[220:223], v5, s[4:7], s18 offen offset:3072
    s_add_u32 s18, s18, 4096
    v_mfma_f32_16x16x32_bf16 v[116:119], a[116:119], v[228:231], v[116:119]
    v_mfma_f32_16x16x32_bf16 v[120:123], a[120:123], v[228:231], v[120:123]
    v_mfma_f32_16x16x32_bf16 v[124:127], a[124:127], v[228:231], v[124:127]
    s_waitcnt vmcnt(30)
    s_barrier
    ds_read_b128 v[8:11], v7 offset:0
    s_waitcnt lgkmcnt(4)
    v_mfma_f32_16x16x32_bf16 v[128:131], a[112:115], v[232:235], v[128:131]
    v_mfma_f32_16x16x32_bf16 v[132:135], a[116:119], v[232:235], v[132:135]
    ds_read_b128 v[12:15], v7 offset:1024
    v_mfma_f32_16x16x32_bf16 v[136:139], a[120:123], v[232:235], v[136:139]
    v_mfma_f32_16x16x32_bf16 v[140:143], a[124:127], v[232:235], v[140:143]
    ds_read_b128 v[16:19], v7 offset:2048
    s_waitcnt lgkmcnt(5)
    v_mfma_f32_16x16x32_bf16 v[144:147], a[112:115], v[236:239], v[144:147]
    v_mfma_f32_16x16x32_bf16 v[148:151], a[116:119], v[236:239], v[148:151]
    ds_read_b128 v[20:23], v7 offset:3072
    v_mfma_f32_16x16x32_bf16 v[152:155], a[120:123], v[236:239], v[152:155]
    v_mfma_f32_16x16x32_bf16 v[156:159], a[124:127], v[236:239], v[156:159]
    ds_read_b128 v[24:27], v7 offset:4096
    s_waitcnt lgkmcnt(6)
    v_mfma_f32_16x16x32_bf16 v[160:163], a[112:115], v[240:243], v[160:163]
    v_mfma_f32_16x16x32_bf16 v[164:167], a[116:119], v[240:243], v[164:167]
    ds_read_b128 v[28:31], v7 offset:5120
    v_mfma_f32_16x16x32_bf16 v[168:171], a[120:123], v[240:243], v[168:171]
    v_mfma_f32_16x16x32_bf16 v[172:175], a[124:127], v[240:243], v[172:175]
    ds_read_b128 v[32:35], v7 offset:6144
    s_waitcnt lgkmcnt(7)
    v_mfma_f32_16x16x32_bf16 v[176:179], a[112:115], v[244:247], v[176:179]
    v_mfma_f32_16x16x32_bf16 v[180:183], a[116:119], v[244:247], v[180:183]
    ds_read_b128 v[36:39], v7 offset:7168
    v_mfma_f32_16x16x32_bf16 v[184:187], a[120:123], v[244:247], v[184:187]
    v_mfma_f32_16x16x32_bf16 v[188:191], a[124:127], v[244:247], v[188:191]
    s_waitcnt lgkmcnt(7)
    v_mfma_f32_16x16x32_bf16 v[64:67], a[128:131], v[8:11], v[64:67]
    v_mfma_f32_16x16x32_bf16 v[68:71], a[132:135], v[8:11], v[68:71]
    v_mfma_f32_16x16x32_bf16 v[72:75], a[136:139], v[8:11], v[72:75]
    v_mfma_f32_16x16x32_bf16 v[76:79], a[140:143], v[8:11], v[76:79]
    s_waitcnt lgkmcnt(6)
    v_mfma_f32_16x16x32_bf16 v[80:83], a[128:131], v[12:15], v[80:83]
    v_mfma_f32_16x16x32_bf16 v[84:87], a[132:135], v[12:15], v[84:87]
    v_mfma_f32_16x16x32_bf16 v[88:91], a[136:139], v[12:15], v[88:91]
    v_mfma_f32_16x16x32_bf16 v[92:95], a[140:143], v[12:15], v[92:95]
    s_waitcnt lgkmcnt(5)
    v_mfma_f32_16x16x32_bf16 v[96:99], a[128:131], v[16:19], v[96:99]
    v_mfma_f32_16x16x32_bf16 v[100:103], a[132:135], v[16:19], v[100:103]
    v_mfma_f32_16x16x32_bf16 v[104:107], a[136:139], v[16:19], v[104:107]
    v_mfma_f32_16x16x32_bf16 v[108:111], a[140:143], v[16:19], v[108:111]
    s_waitcnt lgkmcnt(4)
    v_mfma_f32_16x16x32_bf16 v[112:115], a[128:131], v[20:23], v[112:115]
    v_mfma_f32_16x16x32_bf16 v[116:119], a[132:135], v[20:23], v[116:119]
    v_mfma_f32_16x16x32_bf16 v[120:123], a[136:139], v[20:23], v[120:123]
    v_mfma_f32_16x16x32_bf16 v[124:127], a[140:143], v[20:23], v[124:127]
    s_waitcnt vmcnt(24)
    s_barrier
    ds_read_b128 v[216:219], v7 offset:8192
    s_waitcnt lgkmcnt(4)
    v_mfma_f32_16x16x32_bf16 v[128:131], a[128:131], v[24:27], v[128:131]
    v_mfma_f32_16x16x32_bf16 v[132:135], a[132:135], v[24:27], v[132:135]
    ds_read_b128 v[220:223], v7 offset:9216
    v_mfma_f32_16x16x32_bf16 v[136:139], a[136:139], v[24:27], v[136:139]
    v_mfma_f32_16x16x32_bf16 v[140:143], a[140:143], v[24:27], v[140:143]
    ds_read_b128 v[224:227], v7 offset:10240
    s_waitcnt lgkmcnt(5)
    v_mfma_f32_16x16x32_bf16 v[144:147], a[128:131], v[28:31], v[144:147]
    v_mfma_f32_16x16x32_bf16 v[148:151], a[132:135], v[28:31], v[148:151]
    ds_read_b128 v[228:231], v7 offset:11264
    v_mfma_f32_16x16x32_bf16 v[152:155], a[136:139], v[28:31], v[152:155]
    v_mfma_f32_16x16x32_bf16 v[156:159], a[140:143], v[28:31], v[156:159]
    ds_read_b128 v[232:235], v7 offset:12288
    s_waitcnt lgkmcnt(6)
    v_mfma_f32_16x16x32_bf16 v[160:163], a[128:131], v[32:35], v[160:163]
    v_mfma_f32_16x16x32_bf16 v[164:167], a[132:135], v[32:35], v[164:167]
    ds_read_b128 v[236:239], v7 offset:13312
    v_mfma_f32_16x16x32_bf16 v[168:171], a[136:139], v[32:35], v[168:171]
    v_mfma_f32_16x16x32_bf16 v[172:175], a[140:143], v[32:35], v[172:175]
    ds_read_b128 v[240:243], v7 offset:14336
    s_waitcnt lgkmcnt(7)
    v_mfma_f32_16x16x32_bf16 v[176:179], a[128:131], v[36:39], v[176:179]
    v_mfma_f32_16x16x32_bf16 v[180:183], a[132:135], v[36:39], v[180:183]
    ds_read_b128 v[244:247], v7 offset:15360
    v_mfma_f32_16x16x32_bf16 v[184:187], a[136:139], v[36:39], v[184:187]
    v_mfma_f32_16x16x32_bf16 v[188:191], a[140:143], v[36:39], v[188:191]
    s_waitcnt lgkmcnt(7)
    v_mfma_f32_16x16x32_bf16 v[64:67], a[144:147], v[216:219], v[64:67]
    v_mfma_f32_16x16x32_bf16 v[68:71], a[148:151], v[216:219], v[68:71]
    v_mfma_f32_16x16x32_bf16 v[72:75], a[152:155], v[216:219], v[72:75]
    v_mfma_f32_16x16x32_bf16 v[76:79], a[156:159], v[216:219], v[76:79]
    s_waitcnt lgkmcnt(6)
    v_mfma_f32_16x16x32_bf16 v[80:83], a[144:147], v[220:223], v[80:83]
    v_mfma_f32_16x16x32_bf16 v[84:87], a[148:151], v[220:223], v[84:87]
    v_mfma_f32_16x16x32_bf16 v[88:91], a[152:155], v[220:223], v[88:91]
    v_mfma_f32_16x16x32_bf16 v[92:95], a[156:159], v[220:223], v[92:95]
    s_waitcnt lgkmcnt(5)
    v_mfma_f32_16x16x32_bf16 v[96:99], a[144:147], v[224:227], v[96:99]
    v_mfma_f32_16x16x32_bf16 v[100:103], a[148:151], v[224:227], v[100:103]
    v_mfma_f32_16x16x32_bf16 v[104:107], a[152:155], v[224:227], v[104:107]
    v_mfma_f32_16x16x32_bf16 v[108:111], a[156:159], v[224:227], v[108:111]
    s_waitcnt lgkmcnt(4)
    v_mfma_f32_16x16x32_bf16 v[112:115], a[144:147], v[228:231], v[112:115]
    v_mfma_f32_16x16x32_bf16 v[116:119], a[148:151], v[228:231], v[116:119]
    v_mfma_f32_16x16x32_bf16 v[120:123], a[152:155], v[228:231], v[120:123]
    v_mfma_f32_16x16x32_bf16 v[124:127], a[156:159], v[228:231], v[124:127]
    s_waitcnt vmcnt(18)
    s_barrier
    ds_read_b128 v[8:11], v7 offset:16384
    s_waitcnt lgkmcnt(4)
    v_mfma_f32_16x16x32_bf16 v[128:131], a[144:147], v[232:235], v[128:131]
    v_mfma_f32_16x16x32_bf16 v[132:135], a[148:151], v[232:235], v[132:135]
    ds_read_b128 v[12:15], v7 offset:17408
    v_mfma_f32_16x16x32_bf16 v[136:139], a[152:155], v[232:235], v[136:139]
    v_mfma_f32_16x16x32_bf16 v[140:143], a[156:159], v[232:235], v[140:143]
    ds_read_b128 v[16:19], v7 offset:18432
    s_waitcnt lgkmcnt(5)
    v_mfma_f32_16x16x32_bf16 v[144:147], a[144:147], v[236:239], v[144:147]
    v_mfma_f32_16x16x32_bf16 v[148:151], a[148:151], v[236:239], v[148:151]
    ds_read_b128 v[20:23], v7 offset:19456
    v_mfma_f32_16x16x32_bf16 v[152:155], a[152:155], v[236:239], v[152:155]
    v_mfma_f32_16x16x32_bf16 v[156:159], a[156:159], v[236:239], v[156:159]
    ds_read_b128 v[24:27], v7 offset:20480
    s_waitcnt lgkmcnt(6)
    v_mfma_f32_16x16x32_bf16 v[160:163], a[144:147], v[240:243], v[160:163]
    v_mfma_f32_16x16x32_bf16 v[164:167], a[148:151], v[240:243], v[164:167]
    ds_read_b128 v[28:31], v7 offset:21504
    v_mfma_f32_16x16x32_bf16 v[168:171], a[152:155], v[240:243], v[168:171]
    v_mfma_f32_16x16x32_bf16 v[172:175], a[156:159], v[240:243], v[172:175]
    ds_read_b128 v[32:35], v7 offset:22528
    s_waitcnt lgkmcnt(7)
    v_mfma_f32_16x16x32_bf16 v[176:179], a[144:147], v[244:247], v[176:179]
    v_mfma_f32_16x16x32_bf16 v[180:183], a[148:151], v[244:247], v[180:183]
    ds_read_b128 v[36:39], v7 offset:23552
    v_mfma_f32_16x16x32_bf16 v[184:187], a[152:155], v[244:247], v[184:187]
    v_mfma_f32_16x16x32_bf16 v[188:191], a[156:159], v[244:247], v[188:191]
    s_waitcnt lgkmcnt(7)
    v_mfma_f32_16x16x32_bf16 v[64:67], a[160:163], v[8:11], v[64:67]
    v_mfma_f32_16x16x32_bf16 v[68:71], a[164:167], v[8:11], v[68:71]
    v_mfma_f32_16x16x32_bf16 v[72:75], a[168:171], v[8:11], v[72:75]
    v_mfma_f32_16x16x32_bf16 v[76:79], a[172:175], v[8:11], v[76:79]
    s_waitcnt lgkmcnt(6)
    v_mfma_f32_16x16x32_bf16 v[80:83], a[160:163], v[12:15], v[80:83]
    v_mfma_f32_16x16x32_bf16 v[84:87], a[164:167], v[12:15], v[84:87]
    v_mfma_f32_16x16x32_bf16 v[88:91], a[168:171], v[12:15], v[88:91]
    v_mfma_f32_16x16x32_bf16 v[92:95], a[172:175], v[12:15], v[92:95]
    s_waitcnt lgkmcnt(5)
    v_mfma_f32_16x16x32_bf16 v[96:99], a[160:163], v[16:19], v[96:99]
    v_mfma_f32_16x16x32_bf16 v[100:103], a[164:167], v[16:19], v[100:103]
    v_mfma_f32_16x16x32_bf16 v[104:107], a[168:171], v[16:19], v[104:107]
    v_mfma_f32_16x16x32_bf16 v[108:111], a[172:175], v[16:19], v[108:111]
    s_waitcnt lgkmcnt(4)
    v_mfma_f32_16x16x32_bf16 v[112:115], a[160:163], v[20:23], v[112:115]
    v_mfma_f32_16x16x32_bf16 v[116:119], a[164:167], v[20:23], v[116:119]
    v_mfma_f32_16x16x32_bf16 v[120:123], a[168:171], v[20:23], v[120:123]
    v_mfma_f32_16x16x32_bf16 v[124:127], a[172:175], v[20:23], v[124:127]
    s_waitcnt vmcnt(12)
    s_barrier
    ds_read_b128 v[216:219], v7 offset:24576
    s_waitcnt lgkmcnt(4)
    v_mfma_f32_16x16x32_bf16 v[128:131], a[160:163], v[24:27], v[128:131]
    v_mfma_f32_16x16x32_bf16 v[132:135], a[164:167], v[24:27], v[132:135]
    ds_read_b128 v[220:223], v7 offset:25600
    v_mfma_f32_16x16x32_bf16 v[136:139], a[168:171], v[24:27], v[136:139]
    v_mfma_f32_16x16x32_bf16 v[140:143], a[172:175], v[24:27], v[140:143]
    ds_read_b128 v[224:227], v7 offset:26624
    s_waitcnt lgkmcnt(5)
    v_mfma_f32_16x16x32_bf16 v[144:147], a[160:163], v[28:31], v[144:147]
    v_mfma_f32_16x16x32_bf16 v[148:151], a[164:167], v[28:31], v[148:151]
    ds_read_b128 v[228:231], v7 offset:27648
    v_mfma_f32_16x16x32_bf16 v[152:155], a[168:171], v[28:31], v[152:155]
    v_mfma_f32_16x16x32_bf16 v[156:159], a[172:175], v[28:31], v[156:159]
    ds_read_b128 v[232:235], v7 offset:28672
    s_waitcnt lgkmcnt(6)
    v_mfma_f32_16x16x32_bf16 v[160:163], a[160:163], v[32:35], v[160:163]
    v_mfma_f32_16x16x32_bf16 v[164:167], a[164:167], v[32:35], v[164:167]
    ds_read_b128 v[236:239], v7 offset:29696
    v_mfma_f32_16x16x32_bf16 v[168:171], a[168:171], v[32:35], v[168:171]
    v_mfma_f32_16x16x32_bf16 v[172:175], a[172:175], v[32:35], v[172:175]
    ds_read_b128 v[240:243], v7 offset:30720
    s_waitcnt lgkmcnt(7)
    v_mfma_f32_16x16x32_bf16 v[176:179], a[160:163], v[36:39], v[176:179]
    v_mfma_f32_16x16x32_bf16 v[180:183], a[164:167], v[36:39], v[180:183]
    ds_read_b128 v[244:247], v7 offset:31744
    v_mfma_f32_16x16x32_bf16 v[184:187], a[168:171], v[36:39], v[184:187]
    v_mfma_f32_16x16x32_bf16 v[188:191], a[172:175], v[36:39], v[188:191]
    s_waitcnt lgkmcnt(7)
    v_mfma_f32_16x16x32_bf16 v[64:67], a[176:179], v[216:219], v[64:67]
    v_mfma_f32_16x16x32_bf16 v[68:71], a[180:183], v[216:219], v[68:71]
    v_mfma_f32_16x16x32_bf16 v[72:75], a[184:187], v[216:219], v[72:75]
    v_mfma_f32_16x16x32_bf16 v[76:79], a[188:191], v[216:219], v[76:79]
    s_waitcnt lgkmcnt(6)
    v_mfma_f32_16x16x32_bf16 v[80:83], a[176:179], v[220:223], v[80:83]
    v_mfma_f32_16x16x32_bf16 v[84:87], a[180:183], v[220:223], v[84:87]
    v_mfma_f32_16x16x32_bf16 v[88:91], a[184:187], v[220:223], v[88:91]
    v_mfma_f32_16x16x32_bf16 v[92:95], a[188:191], v[220:223], v[92:95]
    s_waitcnt lgkmcnt(5)
    v_mfma_f32_16x16x32_bf16 v[96:99], a[176:179], v[224:227], v[96:99]
    v_mfma_f32_16x16x32_bf16 v[100:103], a[180:183], v[224:227], v[100:103]
    v_mfma_f32_16x16x32_bf16 v[104:107], a[184:187], v[224:227], v[104:107]
    v_mfma_f32_16x16x32_bf16 v[108:111], a[188:191], v[224:227], v[108:111]
    s_waitcnt lgkmcnt(4)
    v_mfma_f32_16x16x32_bf16 v[112:115], a[176:179], v[228:231], v[112:115]
    v_mfma_f32_16x16x32_bf16 v[116:119], a[180:183], v[228:231], v[116:119]
    v_mfma_f32_16x16x32_bf16 v[120:123], a[184:187], v[228:231], v[120:123]
    v_mfma_f32_16x16x32_bf16 v[124:127], a[188:191], v[228:231], v[124:127]
    s_waitcnt vmcnt(6)
    s_barrier
    ds_read_b128 v[8:11], v7 offset:32768
    s_waitcnt lgkmcnt(4)
    v_mfma_f32_16x16x32_bf16 v[128:131], a[176:179], v[232:235], v[128:131]
    v_mfma_f32_16x16x32_bf16 v[132:135], a[180:183], v[232:235], v[132:135]
    ds_read_b128 v[12:15], v7 offset:33792
    v_mfma_f32_16x16x32_bf16 v[136:139], a[184:187], v[232:235], v[136:139]
    v_mfma_f32_16x16x32_bf16 v[140:143], a[188:191], v[232:235], v[140:143]
    ds_read_b128 v[16:19], v7 offset:34816
    s_waitcnt lgkmcnt(5)
    v_mfma_f32_16x16x32_bf16 v[144:147], a[176:179], v[236:239], v[144:147]
    v_mfma_f32_16x16x32_bf16 v[148:151], a[180:183], v[236:239], v[148:151]
    ds_read_b128 v[20:23], v7 offset:35840
    v_mfma_f32_16x16x32_bf16 v[152:155], a[184:187], v[236:239], v[152:155]
    v_mfma_f32_16x16x32_bf16 v[156:159], a[188:191], v[236:239], v[156:159]
    ds_read_b128 v[24:27], v7 offset:36864
    s_waitcnt lgkmcnt(6)
    v_mfma_f32_16x16x32_bf16 v[160:163], a[176:179], v[240:243], v[160:163]
    v_mfma_f32_16x16x32_bf16 v[164:167], a[180:183], v[240:243], v[164:167]
    ds_read_b128 v[28:31], v7 offset:37888
    v_mfma_f32_16x16x32_bf16 v[168:171], a[184:187], v[240:243], v[168:171]
    v_mfma_f32_16x16x32_bf16 v[172:175], a[188:191], v[240:243], v[172:175]
    ds_read_b128 v[32:35], v7 offset:38912
    s_waitcnt lgkmcnt(7)
    v_mfma_f32_16x16x32_bf16 v[176:179], a[176:179], v[244:247], v[176:179]
    v_mfma_f32_16x16x32_bf16 v[180:183], a[180:183], v[244:247], v[180:183]
    ds_read_b128 v[36:39], v7 offset:39936
    v_mfma_f32_16x16x32_bf16 v[184:187], a[184:187], v[244:247], v[184:187]
    v_mfma_f32_16x16x32_bf16 v[188:191], a[188:191], v[244:247], v[188:191]
    s_waitcnt lgkmcnt(7)
    v_mfma_f32_16x16x32_bf16 v[64:67], a[192:195], v[8:11], v[64:67]
    v_mfma_f32_16x16x32_bf16 v[68:71], a[196:199], v[8:11], v[68:71]
    v_mfma_f32_16x16x32_bf16 v[72:75], a[200:203], v[8:11], v[72:75]
    v_mfma_f32_16x16x32_bf16 v[76:79], a[204:207], v[8:11], v[76:79]
    s_waitcnt lgkmcnt(6)
    v_mfma_f32_16x16x32_bf16 v[80:83], a[192:195], v[12:15], v[80:83]
    v_mfma_f32_16x16x32_bf16 v[84:87], a[196:199], v[12:15], v[84:87]
    v_mfma_f32_16x16x32_bf16 v[88:91], a[200:203], v[12:15], v[88:91]
    v_mfma_f32_16x16x32_bf16 v[92:95], a[204:207], v[12:15], v[92:95]
    s_waitcnt lgkmcnt(5)
    v_mfma_f32_16x16x32_bf16 v[96:99], a[192:195], v[16:19], v[96:99]
    v_mfma_f32_16x16x32_bf16 v[100:103], a[196:199], v[16:19], v[100:103]
    v_mfma_f32_16x16x32_bf16 v[104:107], a[200:203], v[16:19], v[104:107]
    v_mfma_f32_16x16x32_bf16 v[108:111], a[204:207], v[16:19], v[108:111]
    s_waitcnt lgkmcnt(4)
    v_mfma_f32_16x16x32_bf16 v[112:115], a[192:195], v[20:23], v[112:115]
    v_mfma_f32_16x16x32_bf16 v[116:119], a[196:199], v[20:23], v[116:119]
    v_mfma_f32_16x16x32_bf16 v[120:123], a[200:203], v[20:23], v[120:123]
    v_mfma_f32_16x16x32_bf16 v[124:127], a[204:207], v[20:23], v[124:127]
    s_waitcnt vmcnt(0)
    s_barrier
    ds_read_b128 v[216:219], v7 offset:40960
    s_waitcnt lgkmcnt(4)
    v_mfma_f32_16x16x32_bf16 v[128:131], a[192:195], v[24:27], v[128:131]
    v_mfma_f32_16x16x32_bf16 v[132:135], a[196:199], v[24:27], v[132:135]
    ds_read_b128 v[220:223], v7 offset:41984
    v_mfma_f32_16x16x32_bf16 v[136:139], a[200:203], v[24:27], v[136:139]
    v_mfma_f32_16x16x32_bf16 v[140:143], a[204:207], v[24:27], v[140:143]
    ds_read_b128 v[224:227], v7 offset:43008
    s_waitcnt lgkmcnt(5)
    v_mfma_f32_16x16x32_bf16 v[144:147], a[192:195], v[28:31], v[144:147]
    v_mfma_f32_16x16x32_bf16 v[148:151], a[196:199], v[28:31], v[148:151]
    ds_read_b128 v[228:231], v7 offset:44032
    v_mfma_f32_16x16x32_bf16 v[152:155], a[200:203], v[28:31], v[152:155]
    v_mfma_f32_16x16x32_bf16 v[156:159], a[204:207], v[28:31], v[156:159]
    ds_read_b128 v[232:235], v7 offset:45056
    s_waitcnt lgkmcnt(6)
    v_mfma_f32_16x16x32_bf16 v[160:163], a[192:195], v[32:35], v[160:163]
    v_mfma_f32_16x16x32_bf16 v[164:167], a[196:199], v[32:35], v[164:167]
    ds_read_b128 v[236:239], v7 offset:46080
    v_mfma_f32_16x16x32_bf16 v[168:171], a[200:203], v[32:35], v[168:171]
    v_mfma_f32_16x16x32_bf16 v[172:175], a[204:207], v[32:35], v[172:175]
    ds_read_b128 v[240:243], v7 offset:47104
    s_waitcnt lgkmcnt(7)
    v_mfma_f32_16x16x32_bf16 v[176:179], a[192:195], v[36:39], v[176:179]
    v_mfma_f32_16x16x32_bf16 v[180:183], a[196:199], v[36:39], v[180:183]
    ds_read_b128 v[244:247], v7 offset:48128
    v_mfma_f32_16x16x32_bf16 v[184:187], a[200:203], v[36:39], v[184:187]
    v_mfma_f32_16x16x32_bf16 v[188:191], a[204:207], v[36:39], v[188:191]
    s_waitcnt lgkmcnt(7)
    v_mfma_f32_16x16x32_bf16 v[64:67], a[208:211], v[216:219], v[64:67]
    v_mfma_f32_16x16x32_bf16 v[68:71], a[212:215], v[216:219], v[68:71]
    v_mfma_f32_16x16x32_bf16 v[72:75], a[216:219], v[216:219], v[72:75]
    v_mfma_f32_16x16x32_bf16 v[76:79], a[220:223], v[216:219], v[76:79]
    s_waitcnt lgkmcnt(6)
    v_mfma_f32_16x16x32_bf16 v[80:83], a[208:211], v[220:223], v[80:83]
    v_mfma_f32_16x16x32_bf16 v[84:87], a[212:215], v[220:223], v[84:87]
    v_mfma_f32_16x16x32_bf16 v[88:91], a[216:219], v[220:223], v[88:91]
    v_mfma_f32_16x16x32_bf16 v[92:95], a[220:223], v[220:223], v[92:95]
    s_waitcnt lgkmcnt(5)
    v_mfma_f32_16x16x32_bf16 v[96:99], a[208:211], v[224:227], v[96:99]
    v_mfma_f32_16x16x32_bf16 v[100:103], a[212:215], v[224:227], v[100:103]
    v_mfma_f32_16x16x32_bf16 v[104:107], a[216:219], v[224:227], v[104:107]
    v_mfma_f32_16x16x32_bf16 v[108:111], a[220:223], v[224:227], v[108:111]
    s_waitcnt lgkmcnt(4)
    v_mfma_f32_16x16x32_bf16 v[112:115], a[208:211], v[228:231], v[112:115]
    v_mfma_f32_16x16x32_bf16 v[116:119], a[212:215], v[228:231], v[116:119]
    v_mfma_f32_16x16x32_bf16 v[120:123], a[216:219], v[228:231], v[120:123]
    v_mfma_f32_16x16x32_bf16 v[124:127], a[220:223], v[228:231], v[124:127]
    s_waitcnt lgkmcnt(3)
    v_mfma_f32_16x16x32_bf16 v[128:131], a[208:211], v[232:235], v[128:131]
    v_mfma_f32_16x16x32_bf16 v[132:135], a[212:215], v[232:235], v[132:135]
    v_mfma_f32_16x16x32_bf16 v[136:139], a[216:219], v[232:235], v[136:139]
    v_mfma_f32_16x16x32_bf16 v[140:143], a[220:223], v[232:235], v[140:143]
    s_waitcnt lgkmcnt(2)
    v_mfma_f32_16x16x32_bf16 v[144:147], a[208:211], v[236:239], v[144:147]
    v_mfma_f32_16x16x32_bf16 v[148:151], a[212:215], v[236:239], v[148:151]
    v_mfma_f32_16x16x32_bf16 v[152:155], a[216:219], v[236:239], v[152:155]
    v_mfma_f32_16x16x32_bf16 v[156:159], a[220:223], v[236:239], v[156:159]
    s_waitcnt lgkmcnt(1)
    v_mfma_f32_16x16x32_bf16 v[160:163], a[208:211], v[240:243], v[160:163]
    v_mfma_f32_16x16x32_bf16 v[164:167], a[212:215], v[240:243], v[164:167]
    v_mfma_f32_16x16x32_bf16 v[168:171], a[216:219], v[240:243], v[168:171]
    v_mfma_f32_16x16x32_bf16 v[172:175], a[220:223], v[240:243], v[172:175]
    s_waitcnt lgkmcnt(0)
    v_mfma_f32_16x16x32_bf16 v[176:179], a[208:211], v[244:247], v[176:179]
    v_mfma_f32_16x16x32_bf16 v[180:183], a[212:215], v[244:247], v[180:183]
    v_mfma_f32_16x16x32_bf16 v[184:187], a[216:219], v[244:247], v[184:187]
    v_mfma_f32_16x16x32_bf16 v[188:191], a[220:223], v[244:247], v[188:191]
    v_add_u32 v8, 114688, v6
    ds_read_b64 v[16:17], v8 offset:0
    ds_read_b64 v[18:19], v8 offset:128
    ds_read_b64 v[20:21], v8 offset:256
    ds_read_b64 v[22:23], v8 offset:384
    ds_read_b64 v[24:25], v8 offset:512
    ds_read_b64 v[26:27], v8 offset:640
    ds_read_b64 v[28:29], v8 offset:768
    ds_read_b64 v[30:31], v8 offset:896
    s_lshl_b32 s12, s36, 3
    s_mul_i32 s12, s12, 57344
    s_lshl_b32 s13, s17, 10
    s_add_u32 s12, s12, s13
    s_add_u32 s12, s12, 0xd00000
    s_waitcnt lgkmcnt(0)
    v_mul_f32 v17, v17, v17
    v_pk_fma_f32 v[64:65], v[16:17], v[200:201], v[64:65] op_sel_hi:[0,1,1]
    v_pk_fma_f32 v[72:73], v[16:17], v[208:209], v[72:73] op_sel_hi:[0,1,1]
    v_pk_fma_f32 v[66:67], v[16:17], v[202:203], v[66:67] op_sel_hi:[0,1,1]
    v_pk_fma_f32 v[74:75], v[16:17], v[210:211], v[74:75] op_sel_hi:[0,1,1]
    v_pk_fma_f32 v[68:69], v[16:17], v[204:205], v[68:69] op_sel_hi:[0,1,1]
    v_pk_fma_f32 v[76:77], v[16:17], v[212:213], v[76:77] op_sel_hi:[0,1,1]
    v_pk_fma_f32 v[70:71], v[16:17], v[206:207], v[70:71] op_sel_hi:[0,1,1]
    v_pk_fma_f32 v[78:79], v[16:17], v[214:215], v[78:79] op_sel_hi:[0,1,1]
    v_pk_mul_f32 v[64:65], v[64:65], v[72:73]
    v_pk_mul_f32 v[66:67], v[66:67], v[74:75]
    v_pk_mul_f32 v[68:69], v[68:69], v[76:77]
    v_pk_mul_f32 v[70:71], v[70:71], v[78:79]
    v_pk_mul_f32 v[64:65], v[64:65], v[16:17] op_sel:[0,1] op_sel_hi:[1,1]
    v_pk_mul_f32 v[66:67], v[66:67], v[16:17] op_sel:[0,1] op_sel_hi:[1,1]
    v_pk_mul_f32 v[68:69], v[68:69], v[16:17] op_sel:[0,1] op_sel_hi:[1,1]
    v_pk_mul_f32 v[70:71], v[70:71], v[16:17] op_sel:[0,1] op_sel_hi:[1,1]
    v_cvt_pk_bf16_f32 v32, v64, v65
    v_cvt_pk_bf16_f32 v33, v66, v67
    v_cvt_pk_bf16_f32 v34, v68, v69
    v_cvt_pk_bf16_f32 v35, v70, v71
    buffer_store_dwordx4 v[32:35], v5, s[52:55], s12 offen sc0 sc1
    s_add_u32 s12, s12, 57344
    v_mul_f32 v19, v19, v19
    v_pk_fma_f32 v[80:81], v[18:19], v[200:201], v[80:81] op_sel_hi:[0,1,1]
    v_pk_fma_f32 v[88:89], v[18:19], v[208:209], v[88:89] op_sel_hi:[0,1,1]
    v_pk_fma_f32 v[82:83], v[18:19], v[202:203], v[82:83] op_sel_hi:[0,1,1]
    v_pk_fma_f32 v[90:91], v[18:19], v[210:211], v[90:91] op_sel_hi:[0,1,1]
    v_pk_fma_f32 v[84:85], v[18:19], v[204:205], v[84:85] op_sel_hi:[0,1,1]
    v_pk_fma_f32 v[92:93], v[18:19], v[212:213], v[92:93] op_sel_hi:[0,1,1]
    v_pk_fma_f32 v[86:87], v[18:19], v[206:207], v[86:87] op_sel_hi:[0,1,1]
    v_pk_fma_f32 v[94:95], v[18:19], v[214:215], v[94:95] op_sel_hi:[0,1,1]
    v_pk_mul_f32 v[80:81], v[80:81], v[88:89]
    v_pk_mul_f32 v[82:83], v[82:83], v[90:91]
    v_pk_mul_f32 v[84:85], v[84:85], v[92:93]
    v_pk_mul_f32 v[86:87], v[86:87], v[94:95]
    v_pk_mul_f32 v[80:81], v[80:81], v[18:19] op_sel:[0,1] op_sel_hi:[1,1]
    v_pk_mul_f32 v[82:83], v[82:83], v[18:19] op_sel:[0,1] op_sel_hi:[1,1]
    v_pk_mul_f32 v[84:85], v[84:85], v[18:19] op_sel:[0,1] op_sel_hi:[1,1]
    v_pk_mul_f32 v[86:87], v[86:87], v[18:19] op_sel:[0,1] op_sel_hi:[1,1]
    v_cvt_pk_bf16_f32 v36, v80, v81
    v_cvt_pk_bf16_f32 v37, v82, v83
    v_cvt_pk_bf16_f32 v38, v84, v85
    v_cvt_pk_bf16_f32 v39, v86, v87
    buffer_store_dwordx4 v[36:39], v5, s[52:55], s12 offen sc0 sc1
    s_add_u32 s12, s12, 57344
    v_mul_f32 v21, v21, v21
    v_pk_fma_f32 v[96:97], v[20:21], v[200:201], v[96:97] op_sel_hi:[0,1,1]
    v_pk_fma_f32 v[104:105], v[20:21], v[208:209], v[104:105] op_sel_hi:[0,1,1]
    v_pk_fma_f32 v[98:99], v[20:21], v[202:203], v[98:99] op_sel_hi:[0,1,1]
    v_pk_fma_f32 v[106:107], v[20:21], v[210:211], v[106:107] op_sel_hi:[0,1,1]
    v_pk_fma_f32 v[100:101], v[20:21], v[204:205], v[100:101] op_sel_hi:[0,1,1]
    v_pk_fma_f32 v[108:109], v[20:21], v[212:213], v[108:109] op_sel_hi:[0,1,1]
    v_pk_fma_f32 v[102:103], v[20:21], v[206:207], v[102:103] op_sel_hi:[0,1,1]
    v_pk_fma_f32 v[110:111], v[20:21], v[214:215], v[110:111] op_sel_hi:[0,1,1]
    v_pk_mul_f32 v[96:97], v[96:97], v[104:105]
    v_pk_mul_f32 v[98:99], v[98:99], v[106:107]
    v_pk_mul_f32 v[100:101], v[100:101], v[108:109]
    v_pk_mul_f32 v[102:103], v[102:103], v[110:111]
    v_pk_mul_f32 v[96:97], v[96:97], v[20:21] op_sel:[0,1] op_sel_hi:[1,1]
    v_pk_mul_f32 v[98:99], v[98:99], v[20:21] op_sel:[0,1] op_sel_hi:[1,1]
    v_pk_mul_f32 v[100:101], v[100:101], v[20:21] op_sel:[0,1] op_sel_hi:[1,1]
    v_pk_mul_f32 v[102:103], v[102:103], v[20:21] op_sel:[0,1] op_sel_hi:[1,1]
    v_cvt_pk_bf16_f32 v40, v96, v97
    v_cvt_pk_bf16_f32 v41, v98, v99
    v_cvt_pk_bf16_f32 v42, v100, v101
    v_cvt_pk_bf16_f32 v43, v102, v103
    buffer_store_dwordx4 v[40:43], v5, s[52:55], s12 offen sc0 sc1
    s_add_u32 s12, s12, 57344
    v_mul_f32 v23, v23, v23
    v_pk_fma_f32 v[112:113], v[22:23], v[200:201], v[112:113] op_sel_hi:[0,1,1]
    v_pk_fma_f32 v[120:121], v[22:23], v[208:209], v[120:121] op_sel_hi:[0,1,1]
    v_pk_fma_f32 v[114:115], v[22:23], v[202:203], v[114:115] op_sel_hi:[0,1,1]
    v_pk_fma_f32 v[122:123], v[22:23], v[210:211], v[122:123] op_sel_hi:[0,1,1]
    v_pk_fma_f32 v[116:117], v[22:23], v[204:205], v[116:117] op_sel_hi:[0,1,1]
    v_pk_fma_f32 v[124:125], v[22:23], v[212:213], v[124:125] op_sel_hi:[0,1,1]
    v_pk_fma_f32 v[118:119], v[22:23], v[206:207], v[118:119] op_sel_hi:[0,1,1]
    v_pk_fma_f32 v[126:127], v[22:23], v[214:215], v[126:127] op_sel_hi:[0,1,1]
    v_pk_mul_f32 v[112:113], v[112:113], v[120:121]
    v_pk_mul_f32 v[114:115], v[114:115], v[122:123]
    v_pk_mul_f32 v[116:117], v[116:117], v[124:125]
    v_pk_mul_f32 v[118:119], v[118:119], v[126:127]
    v_pk_mul_f32 v[112:113], v[112:113], v[22:23] op_sel:[0,1] op_sel_hi:[1,1]
    v_pk_mul_f32 v[114:115], v[114:115], v[22:23] op_sel:[0,1] op_sel_hi:[1,1]
    v_pk_mul_f32 v[116:117], v[116:117], v[22:23] op_sel:[0,1] op_sel_hi:[1,1]
    v_pk_mul_f32 v[118:119], v[118:119], v[22:23] op_sel:[0,1] op_sel_hi:[1,1]
    v_cvt_pk_bf16_f32 v44, v112, v113
    v_cvt_pk_bf16_f32 v45, v114, v115
    v_cvt_pk_bf16_f32 v46, v116, v117
    v_cvt_pk_bf16_f32 v47, v118, v119
    buffer_store_dwordx4 v[44:47], v5, s[52:55], s12 offen sc0 sc1
    s_add_u32 s12, s12, 57344
    v_mul_f32 v25, v25, v25
    v_pk_fma_f32 v[128:129], v[24:25], v[200:201], v[128:129] op_sel_hi:[0,1,1]
    v_pk_fma_f32 v[136:137], v[24:25], v[208:209], v[136:137] op_sel_hi:[0,1,1]
    v_pk_fma_f32 v[130:131], v[24:25], v[202:203], v[130:131] op_sel_hi:[0,1,1]
    v_pk_fma_f32 v[138:139], v[24:25], v[210:211], v[138:139] op_sel_hi:[0,1,1]
    v_pk_fma_f32 v[132:133], v[24:25], v[204:205], v[132:133] op_sel_hi:[0,1,1]
    v_pk_fma_f32 v[140:141], v[24:25], v[212:213], v[140:141] op_sel_hi:[0,1,1]
    v_pk_fma_f32 v[134:135], v[24:25], v[206:207], v[134:135] op_sel_hi:[0,1,1]
    v_pk_fma_f32 v[142:143], v[24:25], v[214:215], v[142:143] op_sel_hi:[0,1,1]
    v_pk_mul_f32 v[128:129], v[128:129], v[136:137]
    v_pk_mul_f32 v[130:131], v[130:131], v[138:139]
    v_pk_mul_f32 v[132:133], v[132:133], v[140:141]
    v_pk_mul_f32 v[134:135], v[134:135], v[142:143]
    v_pk_mul_f32 v[128:129], v[128:129], v[24:25] op_sel:[0,1] op_sel_hi:[1,1]
    v_pk_mul_f32 v[130:131], v[130:131], v[24:25] op_sel:[0,1] op_sel_hi:[1,1]
    v_pk_mul_f32 v[132:133], v[132:133], v[24:25] op_sel:[0,1] op_sel_hi:[1,1]
    v_pk_mul_f32 v[134:135], v[134:135], v[24:25] op_sel:[0,1] op_sel_hi:[1,1]
    v_cvt_pk_bf16_f32 v32, v128, v129
    v_cvt_pk_bf16_f32 v33, v130, v131
    v_cvt_pk_bf16_f32 v34, v132, v133
    v_cvt_pk_bf16_f32 v35, v134, v135
    buffer_store_dwordx4 v[32:35], v5, s[52:55], s12 offen sc0 sc1
    s_add_u32 s12, s12, 57344
    v_mul_f32 v27, v27, v27
    v_pk_fma_f32 v[144:145], v[26:27], v[200:201], v[144:145] op_sel_hi:[0,1,1]
    v_pk_fma_f32 v[152:153], v[26:27], v[208:209], v[152:153] op_sel_hi:[0,1,1]
    v_pk_fma_f32 v[146:147], v[26:27], v[202:203], v[146:147] op_sel_hi:[0,1,1]
    v_pk_fma_f32 v[154:155], v[26:27], v[210:211], v[154:155] op_sel_hi:[0,1,1]
    v_pk_fma_f32 v[148:149], v[26:27], v[204:205], v[148:149] op_sel_hi:[0,1,1]
    v_pk_fma_f32 v[156:157], v[26:27], v[212:213], v[156:157] op_sel_hi:[0,1,1]
    v_pk_fma_f32 v[150:151], v[26:27], v[206:207], v[150:151] op_sel_hi:[0,1,1]
    v_pk_fma_f32 v[158:159], v[26:27], v[214:215], v[158:159] op_sel_hi:[0,1,1]
    v_pk_mul_f32 v[144:145], v[144:145], v[152:153]
    v_pk_mul_f32 v[146:147], v[146:147], v[154:155]
    v_pk_mul_f32 v[148:149], v[148:149], v[156:157]
    v_pk_mul_f32 v[150:151], v[150:151], v[158:159]
    v_pk_mul_f32 v[144:145], v[144:145], v[26:27] op_sel:[0,1] op_sel_hi:[1,1]
    v_pk_mul_f32 v[146:147], v[146:147], v[26:27] op_sel:[0,1] op_sel_hi:[1,1]
    v_pk_mul_f32 v[148:149], v[148:149], v[26:27] op_sel:[0,1] op_sel_hi:[1,1]
    v_pk_mul_f32 v[150:151], v[150:151], v[26:27] op_sel:[0,1] op_sel_hi:[1,1]
    v_cvt_pk_bf16_f32 v36, v144, v145
    v_cvt_pk_bf16_f32 v37, v146, v147
    v_cvt_pk_bf16_f32 v38, v148, v149
    v_cvt_pk_bf16_f32 v39, v150, v151
    buffer_store_dwordx4 v[36:39], v5, s[52:55], s12 offen sc0 sc1
    s_add_u32 s12, s12, 57344
    v_mul_f32 v29, v29, v29
    v_pk_fma_f32 v[160:161], v[28:29], v[200:201], v[160:161] op_sel_hi:[0,1,1]
    v_pk_fma_f32 v[168:169], v[28:29], v[208:209], v[168:169] op_sel_hi:[0,1,1]
    v_pk_fma_f32 v[162:163], v[28:29], v[202:203], v[162:163] op_sel_hi:[0,1,1]
    v_pk_fma_f32 v[170:171], v[28:29], v[210:211], v[170:171] op_sel_hi:[0,1,1]
    v_pk_fma_f32 v[164:165], v[28:29], v[204:205], v[164:165] op_sel_hi:[0,1,1]
    v_pk_fma_f32 v[172:173], v[28:29], v[212:213], v[172:173] op_sel_hi:[0,1,1]
    v_pk_fma_f32 v[166:167], v[28:29], v[206:207], v[166:167] op_sel_hi:[0,1,1]
    v_pk_fma_f32 v[174:175], v[28:29], v[214:215], v[174:175] op_sel_hi:[0,1,1]
    v_pk_mul_f32 v[160:161], v[160:161], v[168:169]
    v_pk_mul_f32 v[162:163], v[162:163], v[170:171]
    v_pk_mul_f32 v[164:165], v[164:165], v[172:173]
    v_pk_mul_f32 v[166:167], v[166:167], v[174:175]
    v_pk_mul_f32 v[160:161], v[160:161], v[28:29] op_sel:[0,1] op_sel_hi:[1,1]
    v_pk_mul_f32 v[162:163], v[162:163], v[28:29] op_sel:[0,1] op_sel_hi:[1,1]
    v_pk_mul_f32 v[164:165], v[164:165], v[28:29] op_sel:[0,1] op_sel_hi:[1,1]
    v_pk_mul_f32 v[166:167], v[166:167], v[28:29] op_sel:[0,1] op_sel_hi:[1,1]
    v_cvt_pk_bf16_f32 v40, v160, v161
    v_cvt_pk_bf16_f32 v41, v162, v163
    v_cvt_pk_bf16_f32 v42, v164, v165
    v_cvt_pk_bf16_f32 v43, v166, v167
    buffer_store_dwordx4 v[40:43], v5, s[52:55], s12 offen sc0 sc1
    s_add_u32 s12, s12, 57344
    v_mul_f32 v31, v31, v31
    v_pk_fma_f32 v[176:177], v[30:31], v[200:201], v[176:177] op_sel_hi:[0,1,1]
    v_pk_fma_f32 v[184:185], v[30:31], v[208:209], v[184:185] op_sel_hi:[0,1,1]
    v_pk_fma_f32 v[178:179], v[30:31], v[202:203], v[178:179] op_sel_hi:[0,1,1]
    v_pk_fma_f32 v[186:187], v[30:31], v[210:211], v[186:187] op_sel_hi:[0,1,1]
    v_pk_fma_f32 v[180:181], v[30:31], v[204:205], v[180:181] op_sel_hi:[0,1,1]
    v_pk_fma_f32 v[188:189], v[30:31], v[212:213], v[188:189] op_sel_hi:[0,1,1]
    v_pk_fma_f32 v[182:183], v[30:31], v[206:207], v[182:183] op_sel_hi:[0,1,1]
    v_pk_fma_f32 v[190:191], v[30:31], v[214:215], v[190:191] op_sel_hi:[0,1,1]
    v_pk_mul_f32 v[176:177], v[176:177], v[184:185]
    v_pk_mul_f32 v[178:179], v[178:179], v[186:187]
    v_pk_mul_f32 v[180:181], v[180:181], v[188:189]
    v_pk_mul_f32 v[182:183], v[182:183], v[190:191]
    v_pk_mul_f32 v[176:177], v[176:177], v[30:31] op_sel:[0,1] op_sel_hi:[1,1]
    v_pk_mul_f32 v[178:179], v[178:179], v[30:31] op_sel:[0,1] op_sel_hi:[1,1]
    v_pk_mul_f32 v[180:181], v[180:181], v[30:31] op_sel:[0,1] op_sel_hi:[1,1]
    v_pk_mul_f32 v[182:183], v[182:183], v[30:31] op_sel:[0,1] op_sel_hi:[1,1]
    v_cvt_pk_bf16_f32 v44, v176, v177
    v_cvt_pk_bf16_f32 v45, v178, v179
    v_cvt_pk_bf16_f32 v46, v180, v181
    v_cvt_pk_bf16_f32 v47, v182, v183
    buffer_store_dwordx4 v[44:47], v5, s[52:55], s12 offen sc0 sc1
    s_add_u32 s12, s12, 57344
    s_lshl_b32 s41, s36, 9
    s_add_u32 s41, s41, 0x440100
    s_waitcnt vmcnt(0)
    s_barrier
    s_cmp_lg_u32 s3, 0
    s_cbranch_scc1 L_sig_34
    s_mov_b64 exec, 1
    v_mov_b32 v254, 1
    v_mov_b32 v255, 0
    buffer_atomic_add v254, v255, s[52:55], s41 offen sc1
    s_mov_b64 exec, -1
L_sig_34:
    s_cmp_ge_u32 s37, 7
    s_cselect_b32 s10, 1, 0
    s_mul_i32 s11, s10, 7
    s_sub_u32 s11, s37, s11
    s_lshl_b32 s8, s36, 1
    s_add_u32 s10, s10, s8
    s_mul_i32 s12, s10, 229376
    s_mul_i32 s13, s3, 14336
    s_add_u32 s12, s12, s13
    s_add_u32 s12, s12, 0xd00000
    s_add_u32 s13, s12, 57344
    s_add_u32 s14, s12, 114688
    s_add_u32 s15, s12, 172032
    s_mul_i32 s16, s11, 229376
    s_mul_i32 s20, s3, 14336
    s_add_u32 s16, s16, s20
    s_add_u32 s16, s16, 0xf00000
    s_add_u32 s17, s16, 57344
    s_add_u32 s18, s16, 114688
    s_add_u32 s19, s16, 172032
    s_lshl_b32 s20, s10, 2
    s_add_u32 s20, s20, s3
    s_mul_i32 s21, s20, 14336
    s_lshl_b32 s22, s11, 11
    s_add_u32 s21, s21, s22
    s_add_u32 s24, s21, 0x1800000
    s_add_u32 s21, s21, 0x200000
    buffer_load_dwordx4 a[16:19], v5, s[4:7], s16 offen offset:0
    buffer_load_dwordx4 a[20:23], v5, s[4:7], s17 offen offset:0
    buffer_load_dwordx4 a[24:27], v5, s[4:7], s18 offen offset:0
    buffer_load_dwordx4 a[28:31], v5, s[4:7], s19 offen offset:0
    buffer_load_dwordx4 a[48:51], v5, s[4:7], s16 offen offset:1024
    buffer_load_dwordx4 a[52:55], v5, s[4:7], s17 offen offset:1024
    buffer_load_dwordx4 a[56:59], v5, s[4:7], s18 offen offset:1024
    buffer_load_dwordx4 a[60:63], v5, s[4:7], s19 offen offset:1024
    buffer_load_dwordx4 a[80:83], v5, s[4:7], s16 offen offset:2048
    buffer_load_dwordx4 a[84:87], v5, s[4:7], s17 offen offset:2048
    buffer_load_dwordx4 a[88:91], v5, s[4:7], s18 offen offset:2048
    buffer_load_dwordx4 a[92:95], v5, s[4:7], s19 offen offset:2048
    buffer_load_dwordx4 a[112:115], v5, s[4:7], s16 offen offset:3072
    buffer_load_dwordx4 a[116:119], v5, s[4:7], s17 offen offset:3072
    buffer_load_dwordx4 a[120:123], v5, s[4:7], s18 offen offset:3072
    buffer_load_dwordx4 a[124:127], v5, s[4:7], s19 offen offset:3072
    s_add_u32 s16, s16, 4096
    s_add_u32 s17, s17, 4096
    s_add_u32 s18, s18, 4096
    s_add_u32 s19, s19, 4096
    buffer_load_dwordx4 a[144:147], v5, s[4:7], s16 offen offset:0
    buffer_load_dwordx4 a[148:151], v5, s[4:7], s17 offen offset:0
    buffer_load_dwordx4 a[152:155], v5, s[4:7], s18 offen offset:0
    buffer_load_dwordx4 a[156:159], v5, s[4:7], s19 offen offset:0
    buffer_load_dwordx4 a[176:179], v5, s[4:7], s16 offen offset:1024
    buffer_load_dwordx4 a[180:183], v5, s[4:7], s17 offen offset:1024
    buffer_load_dwordx4 a[184:187], v5, s[4:7], s18 offen offset:1024
    buffer_load_dwordx4 a[188:191], v5, s[4:7], s19 offen offset:1024
    buffer_load_dwordx4 a[208:211], v5, s[4:7], s16 offen offset:2048
    buffer_load_dwordx4 a[212:215], v5, s[4:7], s17 offen offset:2048
    buffer_load_dwordx4 a[216:219], v5, s[4:7], s18 offen offset:2048
    buffer_load_dwordx4 a[220:223], v5, s[4:7], s19 offen offset:2048
    buffer_load_dwordx4 v[8:11], v5, s[52:55], s21 offen
    buffer_load_dwordx4 v[12:15], v5, s[52:55], s21 offen offset:1024
    s_lshl_b32 s41, s36, 9
    s_add_u32 s41, s41, 0x440100
    s_cmp_lg_u32 s3, 0
    s_cbranch_scc1 L_wdone_35
    s_mov_b32 s42, 0x40000
    v_mov_b32 v255, 0
L_wloop_36:
    buffer_load_dword v254, v255, s[52:55], s41 offen sc0 sc1
    s_waitcnt vmcnt(0)
    v_readfirstlane_b32 s43, v254
    s_cmp_ge_u32 s43, 14
    s_cbranch_scc1 L_wdone_35
    s_sub_u32 s42, s42, 1
    s_cmp_eq_u32 s42, 0
    s_cbranch_scc1 L_wdone_35
    s_sleep 1
    s_branch L_wloop_36
L_wdone_35:
    s_barrier
    buffer_load_dwordx4 a[0:3], v5, s[52:55], s12 offen offset:0
    buffer_load_dwordx4 a[4:7], v5, s[52:55], s13 offen offset:0
    buffer_load_dwordx4 a[8:11], v5, s[52:55], s14 offen offset:0
    buffer_load_dwordx4 a[12:15], v5, s[52:55], s15 offen offset:0
    buffer_load_dwordx4 a[32:35], v5, s[52:55], s12 offen offset:1024
    buffer_load_dwordx4 a[36:39], v5, s[52:55], s13 offen offset:1024
    buffer_load_dwordx4 a[40:43], v5, s[52:55], s14 offen offset:1024
    buffer_load_dwordx4 a[44:47], v5, s[52:55], s15 offen offset:1024
    buffer_load_dwordx4 a[64:67], v5, s[52:55], s12 offen offset:2048
    buffer_load_dwordx4 a[68:71], v5, s[52:55], s13 offen offset:2048
    buffer_load_dwordx4 a[72:75], v5, s[52:55], s14 offen offset:2048
    buffer_load_dwordx4 a[76:79], v5, s[52:55], s15 offen offset:2048
    buffer_load_dwordx4 a[96:99], v5, s[52:55], s12 offen offset:3072
    buffer_load_dwordx4 a[100:103], v5, s[52:55], s13 offen offset:3072
    buffer_load_dwordx4 a[104:107], v5, s[52:55], s14 offen offset:3072
    buffer_load_dwordx4 a[108:111], v5, s[52:55], s15 offen offset:3072
    s_add_u32 s12, s12, 4096
    s_add_u32 s13, s13, 4096
    s_add_u32 s14, s14, 4096
    s_add_u32 s15, s15, 4096
    s_waitcnt vmcnt(12)
    buffer_load_dwordx4 a[128:131], v5, s[52:55], s12 offen offset:0
    v_mfma_f32_16x16x32_bf16 v[16:19], a[16:19], a[0:3], 0
    v_mfma_f32_16x16x32_bf16 v[20:23], a[20:23], a[0:3], 0
    buffer_load_dwordx4 a[132:135], v5, s[52:55], s13 offen offset:0
    v_mfma_f32_16x16x32_bf16 v[24:27], a[24:27], a[0:3], 0
    v_mfma_f32_16x16x32_bf16 v[28:31], a[28:31], a[0:3], 0
    buffer_load_dwordx4 a[136:139], v5, s[52:55], s14 offen offset:0
    v_mfma_f32_16x16x32_bf16 v[32:35], a[16:19], a[4:7], 0
    v_mfma_f32_16x16x32_bf16 v[36:39], a[20:23], a[4:7], 0
    buffer_load_dwordx4 a[140:143], v5, s[52:55], s15 offen offset:0
    v_mfma_f32_16x16x32_bf16 v[40:43], a[24:27], a[4:7], 0
    v_mfma_f32_16x16x32_bf16 v[44:47], a[28:31], a[4:7], 0
    buffer_load_dwordx4 a[160:163], v5, s[52:55], s12 offen offset:1024
    v_mfma_f32_16x16x32_bf16 v[48:51], a[16:19], a[8:11], 0
    v_mfma_f32_16x16x32_bf16 v[52:55], a[20:23], a[8:11], 0
    buffer_load_dwordx4 a[164:167], v5, s[52:55], s13 offen offset:1024
    v_mfma_f32_16x16x32_bf16 v[56:59], a[24:27], a[8:11], 0
    v_mfma_f32_16x16x32_bf16 v[60:63], a[28:31], a[8:11], 0
    buffer_load_dwordx4 a[168:171], v5, s[52:55], s14 offen offset:1024
    v_mfma_f32_16x16x32_bf16 v[64:67], a[16:19], a[12:15], 0
    v_mfma_f32_16x16x32_bf16 v[68:71], a[20:23], a[12:15], 0
    buffer_load_dwordx4 a[172:175], v5, s[52:55], s15 offen offset:1024
    v_mfma_f32_16x16x32_bf16 v[72:75], a[24:27], a[12:15], 0
    v_mfma_f32_16x16x32_bf16 v[76:79], a[28:31], a[12:15], 0
    s_waitcnt vmcnt(16)
    buffer_load_dwordx4 a[192:195], v5, s[52:55], s12 offen offset:2048
    v_mfma_f32_16x16x32_bf16 v[16:19], a[48:51], a[32:35], v[16:19]
    buffer_load_dwordx4 a[196:199], v5, s[52:55], s13 offen offset:2048
    v_mfma_f32_16x16x32_bf16 v[20:23], a[52:55], a[32:35], v[20:23]
    buffer_load_dwordx4 a[200:203], v5, s[52:55], s14 offen offset:2048
    v_mfma_f32_16x16x32_bf16 v[24:27], a[56:59], a[32:35], v[24:27]
    v_mfma_f32_16x16x32_bf16 v[28:31], a[60:63], a[32:35], v[28:31]
    buffer_load_dwordx4 a[204:207], v5, s[52:55], s15 offen offset:2048
    v_mfma_f32_16x16x32_bf16 v[32:35], a[48:51], a[36:39], v[32:35]
    buffer_load_dwordx4 a[0:3], v5, s[52:55], s12 offen offset:3072
    v_mfma_f32_16x16x32_bf16 v[36:39], a[52:55], a[36:39], v[36:39]
    buffer_load_dwordx4 a[4:7], v5, s[52:55], s13 offen offset:3072
    v_mfma_f32_16x16x32_bf16 v[40:43], a[56:59], a[36:39], v[40:43]
    v_mfma_f32_16x16x32_bf16 v[44:47], a[60:63], a[36:39], v[44:47]
    buffer_load_dwordx4 a[8:11], v5, s[52:55], s14 offen offset:3072
    v_mfma_f32_16x16x32_bf16 v[48:51], a[48:51], a[40:43], v[48:51]
    buffer_load_dwordx4 a[12:15], v5, s[52:55], s15 offen offset:3072
    s_add_u32 s12, s12, 4096
    s_add_u32 s13, s13, 4096
    s_add_u32 s14, s14, 4096
    s_add_u32 s15, s15, 4096
    v_mfma_f32_16x16x32_bf16 v[52:55], a[52:55], a[40:43], v[52:55]
    buffer_load_dwordx4 a[16:19], v5, s[4:7], s16 offen offset:3072
    v_mfma_f32_16x16x32_bf16 v[56:59], a[56:59], a[40:43], v[56:59]
    v_mfma_f32_16x16x32_bf16 v[60:63], a[60:63], a[40:43], v[60:63]
    buffer_load_dwordx4 a[20:23], v5, s[4:7], s17 offen offset:3072
    v_mfma_f32_16x16x32_bf16 v[64:67], a[48:51], a[44:47], v[64:67]
    buffer_load_dwordx4 a[24:27], v5, s[4:7], s18 offen offset:3072
    v_mfma_f32_16x16x32_bf16 v[68:71], a[52:55], a[44:47], v[68:71]
    buffer_load_dwordx4 a[28:31], v5, s[4:7], s19 offen offset:3072
    s_add_u32 s16, s16, 4096
    s_add_u32 s17, s17, 4096
    s_add_u32 s18, s18, 4096
    s_add_u32 s19, s19, 4096
    v_mfma_f32_16x16x32_bf16 v[72:75], a[56:59], a[44:47], v[72:75]
    v_mfma_f32_16x16x32_bf16 v[76:79], a[60:63], a[44:47], v[76:79]
    s_waitcnt vmcnt(24)
    buffer_load_dwordx4 a[32:35], v5, s[52:55], s12 offen offset:0
    v_mfma_f32_16x16x32_bf16 v[16:19], a[80:83], a[64:67], v[16:19]
    v_mfma_f32_16x16x32_bf16 v[20:23], a[84:87], a[64:67], v[20:23]
    buffer_load_dwordx4 a[36:39], v5, s[52:55], s13 offen offset:0
    v_mfma_f32_16x16x32_bf16 v[24:27], a[88:91], a[64:67], v[24:27]
    v_mfma_f32_16x16x32_bf16 v[28:31], a[92:95], a[64:67], v[28:31]
    buffer_load_dwordx4 a[40:43], v5, s[52:55], s14 offen offset:0
    v_mfma_f32_16x16x32_bf16 v[32:35], a[80:83], a[68:71], v[32:35]
    v_mfma_f32_16x16x32_bf16 v[36:39], a[84:87], a[68:71], v[36:39]
    buffer_load_dwordx4 a[44:47], v5, s[52:55], s15 offen offset:0
    v_mfma_f32_16x16x32_bf16 v[40:43], a[88:91], a[68:71], v[40:43]
    v_mfma_f32_16x16x32_bf16 v[44:47], a[92:95], a[68:71], v[44:47]
    buffer_load_dwordx4 a[48:51], v5, s[4:7], s16 offen offset:0
    v_mfma_f32_16x16x32_bf16 v[48:51], a[80:83], a[72:75], v[48:51]
    v_mfma_f32_16x16x32_bf16 v[52:55], a[84:87], a[72:75], v[52:55]
    buffer_load_dwordx4 a[52:55], v5, s[4:7], s17 offen offset:0
    v_mfma_f32_16x16x32_bf16 v[56:59], a[88:91], a[72:75], v[56:59]
    v_mfma_f32_16x16x32_bf16 v[60:63], a[92:95], a[72:75], v[60:63]
    buffer_load_dwordx4 a[56:59], v5, s[4:7], s18 offen offset:0
    v_mfma_f32_16x16x32_bf16 v[64:67], a[80:83], a[76:79], v[64:67]
    v_mfma_f32_16x16x32_bf16 v[68:71], a[84:87], a[76:79], v[68:71]
    buffer_load_dwordx4 a[60:63], v5, s[4:7], s19 offen offset:0
    v_mfma_f32_16x16x32_bf16 v[72:75], a[88:91], a[76:79], v[72:75]
    v_mfma_f32_16x16x32_bf16 v[76:79], a[92:95], a[76:79], v[76:79]
    s_waitcnt vmcnt(28)
    buffer_load_dwordx4 a[64:67], v5, s[52:55], s12 offen offset:1024
    v_mfma_f32_16x16x32_bf16 v[16:19], a[112:115], a[96:99], v[16:19]
    v_mfma_f32_16x16x32_bf16 v[20:23], a[116:119], a[96:99], v[20:23]
    buffer_load_dwordx4 a[68:71], v5, s[52:55], s13 offen offset:1024
    v_mfma_f32_16x16x32_bf16 v[24:27], a[120:123], a[96:99], v[24:27]
    v_mfma_f32_16x16x32_bf16 v[28:31], a[124:127], a[96:99], v[28:31]
    buffer_load_dwordx4 a[72:75], v5, s[52:55], s14 offen offset:1024
    v_mfma_f32_16x16x32_bf16 v[32:35], a[112:115], a[100:103], v[32:35]
    v_mfma_f32_16x16x32_bf16 v[36:39], a[116:119], a[100:103], v[36:39]
    buffer_load_dwordx4 a[76:79], v5, s[52:55], s15 offen offset:1024
    v_mfma_f32_16x16x32_bf16 v[40:43], a[120:123], a[100:103], v[40:43]
    v_mfma_f32_16x16x32_bf16 v[44:47], a[124:127], a[100:103], v[44:47]
    buffer_load_dwordx4 a[80:83], v5, s[4:7], s16 offen offset:1024
    v_mfma_f32_16x16x32_bf16 v[48:51], a[112:115], a[104:107], v[48:51]
    v_mfma_f32_16x16x32_bf16 v[52:55], a[116:119], a[104:107], v[52:55]
    buffer_load_dwordx4 a[84:87], v5, s[4:7], s17 offen offset:1024
    v_mfma_f32_16x16x32_bf16 v[56:59], a[120:123], a[104:107], v[56:59]
    v_mfma_f32_16x16x32_bf16 v[60:63], a[124:127], a[104:107], v[60:63]
    buffer_load_dwordx4 a[88:91], v5, s[4:7], s18 offen offset:1024
    v_mfma_f32_16x16x32_bf16 v[64:67], a[112:115], a[108:111], v[64:67]
    v_mfma_f32_16x16x32_bf16 v[68:71], a[116:119], a[108:111], v[68:71]
    buffer_load_dwordx4 a[92:95], v5, s[4:7], s19 offen offset:1024
    v_mfma_f32_16x16x32_bf16 v[72:75], a[120:123], a[108:111], v[72:75]
    v_mfma_f32_16x16x32_bf16 v[76:79], a[124:127], a[108:111], v[76:79]
    s_waitcnt vmcnt(32)
    buffer_load_dwordx4 a[96:99], v5, s[52:55], s12 offen offset:2048
    v_mfma_f32_16x16x32_bf16 v[16:19], a[144:147], a[128:131], v[16:19]
    v_mfma_f32_16x16x32_bf16 v[20:23], a[148:151], a[128:131], v[20:23]
    buffer_load_dwordx4 a[100:103], v5, s[52:55], s13 offen offset:2048
    v_mfma_f32_16x16x32_bf16 v[24:27], a[152:155], a[128:131], v[24:27]
    v_mfma_f32_16x16x32_bf16 v[28:31], a[156:159], a[128:131], v[28:31]
    buffer_load_dwordx4 a[104:107], v5, s[52:55], s14 offen offset:2048
    v_mfma_f32_16x16x32_bf16 v[32:35], a[144:147], a[132:135], v[32:35]
    v_mfma_f32_16x16x32_bf16 v[36:39], a[148:151], a[132:135], v[36:39]
    buffer_load_dwordx4 a[108:111], v5, s[52:55], s15 offen offset:2048
    v_mfma_f32_16x16x32_bf16 v[40:43], a[152:155], a[132:135], v[40:43]
    v_mfma_f32_16x16x32_bf16 v[44:47], a[156:159], a[132:135], v[44:47]
    buffer_load_dwordx4 a[112:115], v5, s[4:7], s16 offen offset:2048
    v_mfma_f32_16x16x32_bf16 v[48:51], a[144:147], a[136:139], v[48:51]
    v_mfma_f32_16x16x32_bf16 v[52:55], a[148:151], a[136:139], v[52:55]
    buffer_load_dwordx4 a[116:119], v5, s[4:7], s17 offen offset:2048
    v_mfma_f32_16x16x32_bf16 v[56:59], a[152:155], a[136:139], v[56:59]
    v_mfma_f32_16x16x32_bf16 v[60:63], a[156:159], a[136:139], v[60:63]
    buffer_load_dwordx4 a[120:123], v5, s[4:7], s18 offen offset:2048
    v_mfma_f32_16x16x32_bf16 v[64:67], a[144:147], a[140:143], v[64:67]
    v_mfma_f32_16x16x32_bf16 v[68:71], a[148:151], a[140:143], v[68:71]
    buffer_load_dwordx4 a[124:127], v5, s[4:7], s19 offen offset:2048
    v_mfma_f32_16x16x32_bf16 v[72:75], a[152:155], a[140:143], v[72:75]
    v_mfma_f32_16x16x32_bf16 v[76:79], a[156:159], a[140:143], v[76:79]
    s_waitcnt vmcnt(36)
    buffer_load_dwordx4 a[128:131], v5, s[52:55], s12 offen offset:3072
    v_mfma_f32_16x16x32_bf16 v[16:19], a[176:179], a[160:163], v[16:19]
    v_mfma_f32_16x16x32_bf16 v[20:23], a[180:183], a[160:163], v[20:23]
    buffer_load_dwordx4 a[132:135], v5, s[52:55], s13 offen offset:3072
    v_mfma_f32_16x16x32_bf16 v[24:27], a[184:187], a[160:163], v[24:27]
    v_mfma_f32_16x16x32_bf16 v[28:31], a[188:191], a[160:163], v[28:31]
    buffer_load_dwordx4 a[136:139], v5, s[52:55], s14 offen offset:3072
    v_mfma_f32_16x16x32_bf16 v[32:35], a[176:179], a[164:167], v[32:35]
    v_mfma_f32_16x16x32_bf16 v[36:39], a[180:183], a[164:167], v[36:39]
    buffer_load_dwordx4 a[140:143], v5, s[52:55], s15 offen offset:3072
    s_add_u32 s12, s12, 4096
    s_add_u32 s13, s13, 4096
    s_add_u32 s14, s14, 4096
    s_add_u32 s15, s15, 4096
    v_mfma_f32_16x16x32_bf16 v[40:43], a[184:187], a[164:167], v[40:43]
    v_mfma_f32_16x16x32_bf16 v[44:47], a[188:191], a[164:167], v[44:47]
    buffer_load_dwordx4 a[144:147], v5, s[4:7], s16 offen offset:3072
    v_mfma_f32_16x16x32_bf16 v[48:51], a[176:179], a[168:171], v[48:51]
    v_mfma_f32_16x16x32_bf16 v[52:55], a[180:183], a[168:171], v[52:55]
    buffer_load_dwordx4 a[148:151], v5, s[4:7], s17 offen offset:3072
    v_mfma_f32_16x16x32_bf16 v[56:59], a[184:187], a[168:171], v[56:59]
    v_mfma_f32_16x16x32_bf16 v[60:63], a[188:191], a[168:171], v[60:63]
    buffer_load_dwordx4 a[152:155], v5, s[4:7], s18 offen offset:3072
    v_mfma_f32_16x16x32_bf16 v[64:67], a[176:179], a[172:175], v[64:67]
    v_mfma_f32_16x16x32_bf16 v[68:71], a[180:183], a[172:175], v[68:71]
    buffer_load_dwordx4 a[156:159], v5, s[4:7], s19 offen offset:3072
    s_add_u32 s16, s16, 4096
    s_add_u32 s17, s17, 4096
    s_add_u32 s18, s18, 4096
    s_add_u32 s19, s19, 4096
    v_mfma_f32_16x16x32_bf16 v[72:75], a[184:187], a[172:175], v[72:75]
    v_mfma_f32_16x16x32_bf16 v[76:79], a[188:191], a[172:175], v[76:79]
    s_waitcnt vmcnt(40)
    buffer_load_dwordx4 a[160:163], v5, s[52:55], s12 offen offset:0
    v_mfma_f32_16x16x32_bf16 v[16:19], a[208:211], a[192:195], v[16:19]
    v_mfma_f32_16x16x32_bf16 v[20:23], a[212:215], a[192:195], v[20:23]
    buffer_load_dwordx4 a[164:167], v5, s[52:55], s13 offen offset:0
    v_mfma_f32_16x16x32_bf16 v[24:27], a[216:219], a[192:195], v[24:27]
    v_mfma_f32_16x16x32_bf16 v[28:31], a[220:223], a[192:195], v[28:31]
    buffer_load_dwordx4 a[168:171], v5, s[52:55], s14 offen offset:0
    v_mfma_f32_16x16x32_bf16 v[32:35], a[208:211], a[196:199], v[32:35]
    v_mfma_f32_16x16x32_bf16 v[36:39], a[212:215], a[196:199], v[36:39]
    buffer_load_dwordx4 a[172:175], v5, s[52:55], s15 offen offset:0
    v_mfma_f32_16x16x32_bf16 v[40:43], a[216:219], a[196:199], v[40:43]
    v_mfma_f32_16x16x32_bf16 v[44:47], a[220:223], a[196:199], v[44:47]
    buffer_load_dwordx4 a[176:179], v5, s[4:7], s16 offen offset:0
    v_mfma_f32_16x16x32_bf16 v[48:51], a[208:211], a[200:203], v[48:51]
    v_mfma_f32_16x16x32_bf16 v[52:55], a[212:215], a[200:203], v[52:55]
    buffer_load_dwordx4 a[180:183], v5, s[4:7], s17 offen offset:0
    v_mfma_f32_16x16x32_bf16 v[56:59], a[216:219], a[200:203], v[56:59]
    v_mfma_f32_16x16x32_bf16 v[60:63], a[220:223], a[200:203], v[60:63]
    buffer_load_dwordx4 a[184:187], v5, s[4:7], s18 offen offset:0
    v_mfma_f32_16x16x32_bf16 v[64:67], a[208:211], a[204:207], v[64:67]
    v_mfma_f32_16x16x32_bf16 v[68:71], a[212:215], a[204:207], v[68:71]
    buffer_load_dwordx4 a[188:191], v5, s[4:7], s19 offen offset:0
    v_mfma_f32_16x16x32_bf16 v[72:75], a[216:219], a[204:207], v[72:75]
    v_mfma_f32_16x16x32_bf16 v[76:79], a[220:223], a[204:207], v[76:79]
    s_waitcnt vmcnt(40)
    buffer_load_dwordx4 a[192:195], v5, s[52:55], s12 offen offset:1024
    v_mfma_f32_16x16x32_bf16 v[16:19], a[16:19], a[0:3], v[16:19]
    v_mfma_f32_16x16x32_bf16 v[20:23], a[20:23], a[0:3], v[20:23]
    buffer_load_dwordx4 a[196:199], v5, s[52:55], s13 offen offset:1024
    v_mfma_f32_16x16x32_bf16 v[24:27], a[24:27], a[0:3], v[24:27]
    v_mfma_f32_16x16x32_bf16 v[28:31], a[28:31], a[0:3], v[28:31]
    buffer_load_dwordx4 a[200:203], v5, s[52:55], s14 offen offset:1024
    v_mfma_f32_16x16x32_bf16 v[32:35], a[16:19], a[4:7], v[32:35]
    v_mfma_f32_16x16x32_bf16 v[36:39], a[20:23], a[4:7], v[36:39]
    buffer_load_dwordx4 a[204:207], v5, s[52:55], s15 offen offset:1024
    v_mfma_f32_16x16x32_bf16 v[40:43], a[24:27], a[4:7], v[40:43]
    v_mfma_f32_16x16x32_bf16 v[44:47], a[28:31], a[4:7], v[44:47]
    buffer_load_dwordx4 a[208:211], v5, s[4:7], s16 offen offset:1024
    v_mfma_f32_16x16x32_bf16 v[48:51], a[16:19], a[8:11], v[48:51]
    v_mfma_f32_16x16x32_bf16 v[52:55], a[20:23], a[8:11], v[52:55]
    buffer_load_dwordx4 a[212:215], v5, s[4:7], s17 offen offset:1024
    v_mfma_f32_16x16x32_bf16 v[56:59], a[24:27], a[8:11], v[56:59]
    v_mfma_f32_16x16x32_bf16 v[60:63], a[28:31], a[8:11], v[60:63]
    buffer_load_dwordx4 a[216:219], v5, s[4:7], s18 offen offset:1024
    v_mfma_f32_16x16x32_bf16 v[64:67], a[16:19], a[12:15], v[64:67]
    v_mfma_f32_16x16x32_bf16 v[68:71], a[20:23], a[12:15], v[68:71]
    buffer_load_dwordx4 a[220:223], v5, s[4:7], s19 offen offset:1024
    v_mfma_f32_16x16x32_bf16 v[72:75], a[24:27], a[12:15], v[72:75]
    v_mfma_f32_16x16x32_bf16 v[76:79], a[28:31], a[12:15], v[76:79]
    s_waitcnt vmcnt(40)
    v_mfma_f32_16x16x32_bf16 v[16:19], a[48:51], a[32:35], v[16:19]
    v_mfma_f32_16x16x32_bf16 v[20:23], a[52:55], a[32:35], v[20:23]
    v_mfma_f32_16x16x32_bf16 v[24:27], a[56:59], a[32:35], v[24:27]
    v_mfma_f32_16x16x32_bf16 v[28:31], a[60:63], a[32:35], v[28:31]
    v_mfma_f32_16x16x32_bf16 v[32:35], a[48:51], a[36:39], v[32:35]
    v_mfma_f32_16x16x32_bf16 v[36:39], a[52:55], a[36:39], v[36:39]
    v_mfma_f32_16x16x32_bf16 v[40:43], a[56:59], a[36:39], v[40:43]
    v_mfma_f32_16x16x32_bf16 v[44:47], a[60:63], a[36:39], v[44:47]
    v_mfma_f32_16x16x32_bf16 v[48:51], a[48:51], a[40:43], v[48:51]
    v_mfma_f32_16x16x32_bf16 v[52:55], a[52:55], a[40:43], v[52:55]
    v_mfma_f32_16x16x32_bf16 v[56:59], a[56:59], a[40:43], v[56:59]
    v_mfma_f32_16x16x32_bf16 v[60:63], a[60:63], a[40:43], v[60:63]
    v_mfma_f32_16x16x32_bf16 v[64:67], a[48:51], a[44:47], v[64:67]
    v_mfma_f32_16x16x32_bf16 v[68:71], a[52:55], a[44:47], v[68:71]
    v_mfma_f32_16x16x32_bf16 v[72:75], a[56:59], a[44:47], v[72:75]
    v_mfma_f32_16x16x32_bf16 v[76:79], a[60:63], a[44:47], v[76:79]
    s_waitcnt vmcnt(32)
    v_mfma_f32_16x16x32_bf16 v[16:19], a[80:83], a[64:67], v[16:19]
    v_mfma_f32_16x16x32_bf16 v[20:23], a[84:87], a[64:67], v[20:23]
    v_mfma_f32_16x16x32_bf16 v[24:27], a[88:91], a[64:67], v[24:27]
    v_mfma_f32_16x16x32_bf16 v[28:31], a[92:95], a[64:67], v[28:31]
    v_mfma_f32_16x16x32_bf16 v[32:35], a[80:83], a[68:71], v[32:35]
    v_mfma_f32_16x16x32_bf16 v[36:39], a[84:87], a[68:71], v[36:39]
    v_mfma_f32_16x16x32_bf16 v[40:43], a[88:91], a[68:71], v[40:43]
    v_mfma_f32_16x16x32_bf16 v[44:47], a[92:95], a[68:71], v[44:47]
    v_mfma_f32_16x16x32_bf16 v[48:51], a[80:83], a[72:75], v[48:51]
    v_mfma_f32_16x16x32_bf16 v[52:55], a[84:87], a[72:75], v[52:55]
    v_mfma_f32_16x16x32_bf16 v[56:59], a[88:91], a[72:75], v[56:59]
    v_mfma_f32_16x16x32_bf16 v[60:63], a[92:95], a[72:75], v[60:63]
    v_mfma_f32_16x16x32_bf16 v[64:67], a[80:83], a[76:79], v[64:67]
    v_mfma_f32_16x16x32_bf16 v[68:71], a[84:87], a[76:79], v[68:71]
    v_mfma_f32_16x16x32_bf16 v[72:75], a[88:91], a[76:79], v[72:75]
    v_mfma_f32_16x16x32_bf16 v[76:79], a[92:95], a[76:79], v[76:79]
    s_waitcnt vmcnt(24)
    v_mfma_f32_16x16x32_bf16 v[16:19], a[112:115], a[96:99], v[16:19]
    v_mfma_f32_16x16x32_bf16 v[20:23], a[116:119], a[96:99], v[20:23]
    v_mfma_f32_16x16x32_bf16 v[24:27], a[120:123], a[96:99], v[24:27]
    v_mfma_f32_16x16x32_bf16 v[28:31], a[124:127], a[96:99], v[28:31]
    v_mfma_f32_16x16x32_bf16 v[32:35], a[112:115], a[100:103], v[32:35]
    v_mfma_f32_16x16x32_bf16 v[36:39], a[116:119], a[100:103], v[36:39]
    v_mfma_f32_16x16x32_bf16 v[40:43], a[120:123], a[100:103], v[40:43]
    v_mfma_f32_16x16x32_bf16 v[44:47], a[124:127], a[100:103], v[44:47]
    v_mfma_f32_16x16x32_bf16 v[48:51], a[112:115], a[104:107], v[48:51]
    v_mfma_f32_16x16x32_bf16 v[52:55], a[116:119], a[104:107], v[52:55]
    v_mfma_f32_16x16x32_bf16 v[56:59], a[120:123], a[104:107], v[56:59]
    v_mfma_f32_16x16x32_bf16 v[60:63], a[124:127], a[104:107], v[60:63]
    v_mfma_f32_16x16x32_bf16 v[64:67], a[112:115], a[108:111], v[64:67]
    v_mfma_f32_16x16x32_bf16 v[68:71], a[116:119], a[108:111], v[68:71]
    v_mfma_f32_16x16x32_bf16 v[72:75], a[120:123], a[108:111], v[72:75]
    v_mfma_f32_16x16x32_bf16 v[76:79], a[124:127], a[108:111], v[76:79]
    s_waitcnt vmcnt(16)
    v_mfma_f32_16x16x32_bf16 v[16:19], a[144:147], a[128:131], v[16:19]
    v_mfma_f32_16x16x32_bf16 v[20:23], a[148:151], a[128:131], v[20:23]
    v_mfma_f32_16x16x32_bf16 v[24:27], a[152:155], a[128:131], v[24:27]
    v_mfma_f32_16x16x32_bf16 v[28:31], a[156:159], a[128:131], v[28:31]
    v_mfma_f32_16x16x32_bf16 v[32:35], a[144:147], a[132:135], v[32:35]
    v_mfma_f32_16x16x32_bf16 v[36:39], a[148:151], a[132:135], v[36:39]
    v_mfma_f32_16x16x32_bf16 v[40:43], a[152:155], a[132:135], v[40:43]
    v_mfma_f32_16x16x32_bf16 v[44:47], a[156:159], a[132:135], v[44:47]
    v_mfma_f32_16x16x32_bf16 v[48:51], a[144:147], a[136:139], v[48:51]
    v_mfma_f32_16x16x32_bf16 v[52:55], a[148:151], a[136:139], v[52:55]
    v_mfma_f32_16x16x32_bf16 v[56:59], a[152:155], a[136:139], v[56:59]
    v_mfma_f32_16x16x32_bf16 v[60:63], a[156:159], a[136:139], v[60:63]
    v_mfma_f32_16x16x32_bf16 v[64:67], a[144:147], a[140:143], v[64:67]
    v_mfma_f32_16x16x32_bf16 v[68:71], a[148:151], a[140:143], v[68:71]
    v_mfma_f32_16x16x32_bf16 v[72:75], a[152:155], a[140:143], v[72:75]
    v_mfma_f32_16x16x32_bf16 v[76:79], a[156:159], a[140:143], v[76:79]
    s_waitcnt vmcnt(8)
    v_mfma_f32_16x16x32_bf16 v[16:19], a[176:179], a[160:163], v[16:19]
    v_mfma_f32_16x16x32_bf16 v[20:23], a[180:183], a[160:163], v[20:23]
    v_mfma_f32_16x16x32_bf16 v[24:27], a[184:187], a[160:163], v[24:27]
    v_mfma_f32_16x16x32_bf16 v[28:31], a[188:191], a[160:163], v[28:31]
    v_mfma_f32_16x16x32_bf16 v[32:35], a[176:179], a[164:167], v[32:35]
    v_mfma_f32_16x16x32_bf16 v[36:39], a[180:183], a[164:167], v[36:39]
    v_mfma_f32_16x16x32_bf16 v[40:43], a[184:187], a[164:167], v[40:43]
    v_mfma_f32_16x16x32_bf16 v[44:47], a[188:191], a[164:167], v[44:47]
    v_mfma_f32_16x16x32_bf16 v[48:51], a[176:179], a[168:171], v[48:51]
    v_mfma_f32_16x16x32_bf16 v[52:55], a[180:183], a[168:171], v[52:55]
    v_mfma_f32_16x16x32_bf16 v[56:59], a[184:187], a[168:171], v[56:59]
    v_mfma_f32_16x16x32_bf16 v[60:63], a[188:191], a[168:171], v[60:63]
    v_mfma_f32_16x16x32_bf16 v[64:67], a[176:179], a[172:175], v[64:67]
    v_mfma_f32_16x16x32_bf16 v[68:71], a[180:183], a[172:175], v[68:71]
    v_mfma_f32_16x16x32_bf16 v[72:75], a[184:187], a[172:175], v[72:75]
    v_mfma_f32_16x16x32_bf16 v[76:79], a[188:191], a[172:175], v[76:79]
    s_waitcnt vmcnt(0)
    v_mfma_f32_16x16x32_bf16 v[16:19], a[208:211], a[192:195], v[16:19]
    v_mfma_f32_16x16x32_bf16 v[20:23], a[212:215], a[192:195], v[20:23]
    v_mfma_f32_16x16x32_bf16 v[24:27], a[216:219], a[192:195], v[24:27]
    v_mfma_f32_16x16x32_bf16 v[28:31], a[220:223], a[192:195], v[28:31]
    v_mfma_f32_16x16x32_bf16 v[32:35], a[208:211], a[196:199], v[32:35]
    v_mfma_f32_16x16x32_bf16 v[36:39], a[212:215], a[196:199], v[36:39]
    v_mfma_f32_16x16x32_bf16 v[40:43], a[216:219], a[196:199], v[40:43]
    v_mfma_f32_16x16x32_bf16 v[44:47], a[220:223], a[196:199], v[44:47]
    v_mfma_f32_16x16x32_bf16 v[48:51], a[208:211], a[200:203], v[48:51]
    v_mfma_f32_16x16x32_bf16 v[52:55], a[212:215], a[200:203], v[52:55]
    v_mfma_f32_16x16x32_bf16 v[56:59], a[216:219], a[200:203], v[56:59]
    v_mfma_f32_16x16x32_bf16 v[60:63], a[220:223], a[200:203], v[60:63]
    v_mfma_f32_16x16x32_bf16 v[64:67], a[208:211], a[204:207], v[64:67]
    v_mfma_f32_16x16x32_bf16 v[68:71], a[212:215], a[204:207], v[68:71]
    v_mfma_f32_16x16x32_bf16 v[72:75], a[216:219], a[204:207], v[72:75]
    v_mfma_f32_16x16x32_bf16 v[76:79], a[220:223], a[204:207], v[76:79]
    s_nop 7
    s_lshl_b32 s22, s3, 14
    v_add_u32 v6, s22, v5
    ds_write_b128 v6, v[16:19] offset:0
    ds_write_b128 v6, v[20:23] offset:1024
    ds_write_b128 v6, v[24:27] offset:2048
    ds_write_b128 v6, v[28:31] offset:3072
    ds_write_b128 v6, v[32:35] offset:4096
    ds_write_b128 v6, v[36:39] offset:5120
    ds_write_b128 v6, v[40:43] offset:6144
    ds_write_b128 v6, v[44:47] offset:7168
    ds_write_b128 v6, v[48:51] offset:8192
    ds_write_b128 v6, v[52:55] offset:9216
    ds_write_b128 v6, v[56:59] offset:10240
    ds_write_b128 v6, v[60:63] offset:11264
    ds_write_b128 v6, v[64:67] offset:12288
    ds_write_b128 v6, v[68:71] offset:13312
    ds_write_b128 v6, v[72:75] offset:14336
    ds_write_b128 v6, v[76:79] offset:15360
    s_waitcnt lgkmcnt(0)
    s_barrier
    s_lshl_b32 s22, s3, 12
    v_add_u32 v6, s22, v5
    ds_read_b128 v[80:83], v6 offset:0
    ds_read_b128 v[84:87], v6 offset:1024
    ds_read_b128 v[88:91], v6 offset:2048
    ds_read_b128 v[92:95], v6 offset:3072
    ds_read_b128 v[96:99], v6 offset:16384
    ds_read_b128 v[100:103], v6 offset:17408
    ds_read_b128 v[104:107], v6 offset:18432
    ds_read_b128 v[108:111], v6 offset:19456
    ds_read_b128 v[112:115], v6 offset:32768
    ds_read_b128 v[116:119], v6 offset:33792
    ds_read_b128 v[120:123], v6 offset:34816
    ds_read_b128 v[124:127], v6 offset:35840
    ds_read_b128 v[128:131], v6 offset:49152
    ds_read_b128 v[132:135], v6 offset:50176
    ds_read_b128 v[136:139], v6 offset:51200
    ds_read_b128 v[140:143], v6 offset:52224
    s_waitcnt lgkmcnt(8)
    v_pk_add_f32 v[80:81], v[80:81], v[96:97]
    v_pk_add_f32 v[82:83], v[82:83], v[98:99]
    v_pk_add_f32 v[84:85], v[84:85], v[100:101]
    v_pk_add_f32 v[86:87], v[86:87], v[102:103]
    v_pk_add_f32 v[88:89], v[88:89], v[104:105]
    v_pk_add_f32 v[90:91], v[90:91], v[106:107]
    v_pk_add_f32 v[92:93], v[92:93], v[108:109]
    v_pk_add_f32 v[94:95], v[94:95], v[110:111]
    s_waitcnt lgkmcnt(0)
    v_pk_add_f32 v[112:113], v[112:113], v[128:129]
    v_pk_add_f32 v[114:115], v[114:115], v[130:131]
    v_pk_add_f32 v[116:117], v[116:117], v[132:133]
    v_pk_add_f32 v[118:119], v[118:119], v[134:135]
    v_pk_add_f32 v[120:121], v[120:121], v[136:137]
    v_pk_add_f32 v[122:123], v[122:123], v[138:139]
    v_pk_add_f32 v[124:125], v[124:125], v[140:141]
    v_pk_add_f32 v[126:127], v[126:127], v[142:143]
    v_pk_add_f32 v[80:81], v[80:81], v[112:113]
    v_pk_add_f32 v[82:83], v[82:83], v[114:115]
    v_pk_add_f32 v[84:85], v[84:85], v[116:117]
    v_pk_add_f32 v[86:87], v[86:87], v[118:119]
    v_pk_add_f32 v[88:89], v[88:89], v[120:121]
    v_pk_add_f32 v[90:91], v[90:91], v[122:123]
    v_pk_add_f32 v[92:93], v[92:93], v[124:125]
    v_pk_add_f32 v[94:95], v[94:95], v[126:127]
    v_cvt_pk_bf16_f32 v16, v80, v81
    v_cvt_pk_bf16_f32 v17, v82, v83
    v_cvt_pk_bf16_f32 v18, v84, v85
    v_cvt_pk_bf16_f32 v19, v86, v87
    v_cvt_pk_bf16_f32 v20, v88, v89
    v_cvt_pk_bf16_f32 v21, v90, v91
    v_cvt_pk_bf16_f32 v22, v92, v93
    v_cvt_pk_bf16_f32 v23, v94, v95
    v_lshlrev_b32 v32, 16, v16
    v_and_b32 v33, 0xffff0000, v16
    v_lshlrev_b32 v48, 16, v8
    v_and_b32 v49, 0xffff0000, v8
    v_lshlrev_b32 v34, 16, v17
    v_and_b32 v35, 0xffff0000, v17
    v_lshlrev_b32 v50, 16, v9
    v_and_b32 v51, 0xffff0000, v9
    v_lshlrev_b32 v36, 16, v18
    v_and_b32 v37, 0xffff0000, v18
    v_lshlrev_b32 v52, 16, v10
    v_and_b32 v53, 0xffff0000, v10
    v_lshlrev_b32 v38, 16, v19
    v_and_b32 v39, 0xffff0000, v19
    v_lshlrev_b32 v54, 16, v11
    v_and_b32 v55, 0xffff0000, v11
    v_lshlrev_b32 v40, 16, v20
    v_and_b32 v41, 0xffff0000, v20
    v_lshlrev_b32 v56, 16, v12
    v_and_b32 v57, 0xffff0000, v12
    v_lshlrev_b32 v42, 16, v21
    v_and_b32 v43, 0xffff0000, v21
    v_lshlrev_b32 v58, 16, v13
    v_and_b32 v59, 0xffff0000, v13
    v_lshlrev_b32 v44, 16, v22
    v_and_b32 v45, 0xffff0000, v22
    v_lshlrev_b32 v60, 16, v14
    v_and_b32 v61, 0xffff0000, v14
    v_lshlrev_b32 v46, 16, v23
    v_and_b32 v47, 0xffff0000, v23
    v_lshlrev_b32 v62, 16, v15
    v_and_b32 v63, 0xffff0000, v15
    v_pk_add_f32 v[32:33], v[32:33], v[48:49]
    v_pk_add_f32 v[34:35], v[34:35], v[50:51]
    v_pk_add_f32 v[36:37], v[36:37], v[52:53]
    v_pk_add_f32 v[38:39], v[38:39], v[54:55]
    v_pk_add_f32 v[40:41], v[40:41], v[56:57]
    v_pk_add_f32 v[42:43], v[42:43], v[58:59]
    v_pk_add_f32 v[44:45], v[44:45], v[60:61]
    v_pk_add_f32 v[46:47], v[46:47], v[62:63]
    v_cvt_pk_bf16_f32 v24, v32, v33
    v_cvt_pk_bf16_f32 v25, v34, v35
    v_cvt_pk_bf16_f32 v26, v36, v37
    v_cvt_pk_bf16_f32 v27, v38, v39
    v_cvt_pk_bf16_f32 v28, v40, v41
    v_cvt_pk_bf16_f32 v29, v42, v43
    v_cvt_pk_bf16_f32 v30, v44, v45
    v_cvt_pk_bf16_f32 v31, v46, v47
    s_cmp_eq_u32 s51, 1
    s_cbranch_scc1 L_final_store
    buffer_store_dwordx4 v[24:27], v5, s[52:55], s24 offen sc0 sc1
    buffer_store_dwordx4 v[28:31], v5, s[52:55], s24 offen offset:1024 sc0 sc1
    v_mov_b32 v64, 0
    v_mov_b32 v65, 0
    v_mov_b32 v66, 0
    v_mov_b32 v67, 0
    v_dot2c_f32_bf16 v64, s40, v24
    v_dot2c_f32_bf16 v65, v24, v24
    v_dot2c_f32_bf16 v66, s40, v25
    v_dot2c_f32_bf16 v67, v25, v25
    v_dot2c_f32_bf16 v64, s40, v26
    v_dot2c_f32_bf16 v65, v26, v26
    v_dot2c_f32_bf16 v66, s40, v27
    v_dot2c_f32_bf16 v67, v27, v27
    v_dot2c_f32_bf16 v64, s40, v28
    v_dot2c_f32_bf16 v65, v28, v28
    v_dot2c_f32_bf16 v66, s40, v29
    v_dot2c_f32_bf16 v67, v29, v29
    v_dot2c_f32_bf16 v64, s40, v30
    v_dot2c_f32_bf16 v65, v30, v30
    v_dot2c_f32_bf16 v66, s40, v31
    v_dot2c_f32_bf16 v67, v31, v31
    s_lshl_b32 s22, s20, 7
    s_lshl_b32 s23, s11, 14
    s_add_u32 s22, s22, s23
    s_add_u32 s22, s22, 0x1c00000
    v_lshlrev_b32 v6, 3, v3
    v_pk_add_f32 v[64:65], v[64:65], v[66:67]
    v_mov_b32 v66, v64
    v_mov_b32 v67, v65
    s_nop 1
    v_permlane16_swap_b32 v64, v66
    v_permlane16_swap_b32 v65, v67
    v_add_f32 v64, v64, v66
    v_add_f32 v65, v65, v67
    v_mov_b32 v66, v64
    v_mov_b32 v67, v65
    s_nop 1
    v_permlane32_swap_b32 v64, v66
    v_permlane32_swap_b32 v65, v67
    v_add_f32 v64, v64, v66
    v_add_f32 v65, v65, v67
    buffer_store_dwordx2 v[64:65], v6, s[52:55], s22 offen sc0 sc1
    s_lshl_b32 s41, s36, 9
    s_add_u32 s41, s41, 0x1c40180
    s_waitcnt vmcnt(0)
    s_barrier
    s_cmp_lg_u32 s3, 0
    s_cbranch_scc1 L_sig_37
    s_mov_b64 exec, 1
    v_mov_b32 v254, 1
    v_mov_b32 v255, 0
    buffer_atomic_add v254, v255, s[52:55], s41 offen sc1
    s_mov_b64 exec, -1
L_sig_37:
    s_branch L_final_done
L_final_store:
    s_lshl_b32 s22, s20, 4
    v_add_u32 v6, s22, v3
    v_mul_u32_u24 v6, 896, v6
    v_lshlrev_b32 v7, 3, v4
    v_add_u32 v6, v6, v7
    s_lshl_b32 s22, s11, 7
    buffer_store_dwordx2 v[24:25], v6, s[32:35], s22 offen offset:0
    buffer_store_dwordx2 v[26:27], v6, s[32:35], s22 offen offset:32
    buffer_store_dwordx2 v[28:29], v6, s[32:35], s22 offen offset:64
    buffer_store_dwordx2 v[30:31], v6, s[32:35], s22 offen offset:96
L_final_done:
L_mega_skip:
    s_add_u32 s52, s52, 0x1800000
    s_addc_u32 s53, s53, 0
    s_add_u32 s51, s51, 1
    s_cmp_lt_u32 s51, 2
    s_cbranch_scc1 L_layer
L_mega_end:
    s_endpgm
.section .rodata,"a"
.p2align 6
.amdhsa_kernel prep_kernel
  .amdhsa_next_free_vgpr 96
  .amdhsa_next_free_sgpr 60
  .amdhsa_accum_offset 96
  .amdhsa_group_segment_fixed_size 0
  .amdhsa_kernarg_size 80
  .amdhsa_user_sgpr_count 2
  .amdhsa_user_sgpr_kernarg_segment_ptr 1
  .amdhsa_system_sgpr_workgroup_id_x 1
.end_amdhsa_kernel
.p2align 6
.amdhsa_kernel mega_kernel
  .amdhsa_next_free_vgpr 512
  .amdhsa_next_free_sgpr 60
  .amdhsa_accum_offset 256
  .amdhsa_group_segment_fixed_size 0
  .amdhsa_kernarg_size 80
  .amdhsa_user_sgpr_count 2
  .amdhsa_user_sgpr_kernarg_segment_ptr 1
  .amdhsa_system_sgpr_workgroup_id_x 1
.end_amdhsa_kernel
```
